```python
import torch

def _softmax(x, axis=-1):
    return torch.softmax(x, dim=axis)
def _gelu(x):
    return torch.nn.functional.gelu(x, approximate="tanh")
def _silu(x):
    return torch.nn.functional.silu(x)
def _sigmoid(x):
    return torch.sigmoid(x)
def _layernorm(x, axis=-1, eps=1e-5):
    m = x.mean(dim=axis, keepdim=True)
    v = x.var(dim=axis, keepdim=True, unbiased=False)
    return (x - m) / torch.sqrt(v + eps)
def _scatter_add(tgt, idx, src, axis=0):
    return tgt.clone().index_add_(axis, idx, src)
def _segment_sum(src, seg, n):
    out = torch.zeros((n,) + src.shape[1:], dtype=src.dtype)
    return out.index_add_(0, seg, src)
def _pad(x, pw):
    flat = tuple(v for pair in reversed(pw) for v in pair)
    return torch.nn.functional.pad(x, flat)

kernel_name = 'gated_mix__ssm_conv_h3__glu_gated_reglu__prompt'

def setup_inputs():

    _w = (lambda a: (lambda t: t.to(torch.bfloat16) if t.is_floating_point() else t)(torch.as_tensor(a)))
    def _A_setup():
        B, S, D = 1, 2048, 512
        ks = 4
        return {
            "q": _w((lambda *s: torch.randn(*s, dtype=torch.bfloat16) * 0.05)(B, S, D)),
            "k": _w((lambda *s: torch.randn(*s, dtype=torch.bfloat16) * 0.05)(B, S, D)),
            "v": _w((lambda *s: torch.randn(*s, dtype=torch.bfloat16) * 0.05)(B, S, D)),
            "shift_k": _w((lambda *s: torch.randn(*s, dtype=torch.bfloat16) * 0.05)(D, ks) * 0.5),
            "ssm_k": _w((lambda *s: torch.randn(*s, dtype=torch.bfloat16) * 0.05)(D, S) * (1.0 / S ** 0.5)),
            "ssm_D": _w((lambda *s: torch.randn(*s, dtype=torch.bfloat16) * 0.05)(D)),
        }
    _A_in = _A_setup()

    def _B_setup():
        B, S, D, F = 1, 2048, 512, 1792
        return {
            "x": _w((lambda *s: torch.randn(*s, dtype=torch.bfloat16) * 0.05)(B, S, D)),
            "W_gate": _w((lambda *s: torch.randn(*s, dtype=torch.bfloat16) * 0.05)(D, F) * (2.0 / D) ** 0.5),
            "W_up": _w((lambda *s: torch.randn(*s, dtype=torch.bfloat16) * 0.05)(D, F) * (2.0 / D) ** 0.5),
            "W_down": _w((lambda *s: torch.randn(*s, dtype=torch.bfloat16) * 0.05)(F, D) * (1.0 / F) ** 0.5),
        }
    _B_in = _B_setup()

    return {
        "A_q": _A_in["q"],
        "A_k": _A_in["k"],
        "A_v": _A_in["v"],
        "A_shift_k": _A_in["shift_k"],
        "A_ssm_k": _A_in["ssm_k"],
        "A_ssm_D": _A_in["ssm_D"],
        "B_x": _B_in["x"],
        "B_W_gate": _B_in["W_gate"],
        "B_W_up": _B_in["W_up"],
        "B_W_down": _B_in["W_down"],
        "gate_w": _w((lambda *s: torch.randn(*s, dtype=torch.bfloat16) * 0.05)(512) * 16.0),
    }

def reference(A_q, A_k, A_v, A_shift_k, A_ssm_k, A_ssm_D, B_x, B_W_gate, B_W_up, B_W_down, gate_w):
    def _A_ref(q, k, v, shift_k, ssm_k, ssm_D):
        B, S, D = q.shape
        ks = shift_k.shape[-1]
        k_pad = _pad(k, ((0, 0), (ks - 1, 0), (0, 0)))
        k_shift = torch.zeros_like(k)
        for t in range(ks):
            k_shift = k_shift + k_pad[:, t:t + S, :] * shift_k[:, ks - 1 - t][None, None, :]
        kv = k_shift * v
        L = 2 * S
        kv_pad = _pad(kv, ((0, 0), (0, S), (0, 0)))
        kf_pad = _pad(ssm_k, ((0, 0), (0, S)))
        kv_f = (lambda x, axes=(-2,-1): torch.fft.rfft2(x.float(), dim=axes))(kv_pad[:, None, :, :], axes=(1, 2))
        kf_f = (lambda x, axes=(-2,-1): torch.fft.rfft2(x.float(), dim=axes))(kf_pad[:, None, :], axes=(1, 2))
        kf_f = (lambda x, *d: x.permute(*d))(kf_f, 1, 2, 0)
        y_f = kv_f * kf_f[None, :, :, :]
        y = (lambda x, s, axes=(-2,-1): torch.fft.irfft2(x, s=s, dim=axes).to(torch.bfloat16))(y_f, (1, L), axes=(1, 2))[:, 0, :S, :]
        y = y + kv * ssm_D[None, None, :]
        return q * y

    def _B_ref(x, W_gate, W_up, W_down):
        gate = torch.einsum("bsd,df->bsf", x, W_gate)
        up = torch.einsum("bsd,df->bsf", x, W_up)
        gate = gate * (lambda x, dt: x.to(dt))(gate > 0, gate.dtype)
        h = gate * up
        return torch.einsum("bsf,fd->bsd", h, W_down)

    x = A_q
    g = _sigmoid((x * gate_w).sum(-1, keepdims=True))
    a = _A_ref(x, A_k, A_v, A_shift_k, A_ssm_k, A_ssm_D)
    b = _B_ref(x, B_W_gate, B_W_up, B_W_down)
    return g * a + (1 - g) * b
```

```asm
; @launch grid=(256,1,1) block=(256,1,1) lds=163840
.amdgcn_target "amdgcn-amd-amdhsa--gfx950"
.text
.globl gated_mix__ssm_conv_h3__glu_gated_reglu__prompt_kernel
.p2align 12

.p2align 8
.type gated_mix__ssm_conv_h3__glu_gated_reglu__prompt_kernel,@function
gated_mix__ssm_conv_h3__glu_gated_reglu__prompt_kernel:
    s_cmp_ge_u32 s2, 256
    s_cbranch_scc1 L_end
    s_load_dwordx16 s[16:31], s[0:1], 0
    s_load_dwordx8 s[32:39], s[0:1], 64
    s_load_dwordx4 s[40:43], s[0:1], 96
    v_lshrrev_b32 v1, 6, v0
    v_and_b32 v0, 63, v0
    v_readfirstlane_b32 s88, v1
    v_lshlrev_b32 v1, 4, v0
    s_lshl_b32 s89, s88, 12
    s_mov_b32 s99, 0xffff0000
    s_and_b32 s3, s2, 7
    s_lshr_b32 s4, s2, 3
    s_and_b32 s5, s3, 3
    s_lshr_b32 s6, s3, 2
    s_lshl_b32 s7, s5, 3
    s_lshl_b32 s8, s6, 2
    s_add_u32 s7, s7, s8
    s_and_b32 s8, s4, 3
    s_add_u32 s97, s7, s8
    s_lshr_b32 s98, s4, 2
    s_cmp_lt_u32 s2, 32
    s_cbranch_scc1 L_helper
    s_sub_u32 s4, s4, 4
    s_and_b32 s7, s4, 3
    s_lshr_b32 s8, s4, 2
    s_lshl_b32 s9, s5, 2
    s_add_u32 s9, s9, s7
    s_mul_i32 s10, s6, 7
    s_add_u32 s10, s10, s8
    s_lshl_b32 s11, s5, 1
    s_add_u32 s11, s11, s6
    s_and_b32 s90, s11, 7
    s_lshl_b32 s91, s9, 17
    s_lshl_b32 s11, s88, 15
    s_add_u32 s91, s91, s11
    s_mul_i32 s92, s88, 28672
    s_lshl_b32 s11, s10, 8
    s_add_u32 s92, s92, s11
    v_lshrrev_b32 v28, 3, v0
    v_lshlrev_b32 v28, 10, v28
    v_and_b32 v29, 7, v0
    v_lshrrev_b32 v30, 4, v0
    v_xor_b32 v29, v29, v30
    v_lshl_add_u32 v28, v29, 4, v28
    v_lshrrev_b32 v29, 4, v0
    v_mul_u32_u24 v30, 3584, v29
    v_bfe_u32 v31, v0, 1, 3
    v_lshlrev_b32 v29, 1, v29
    v_xor_b32 v31, v31, v29
    v_and_b32 v29, 1, v0
    v_lshlrev_b32 v29, 4, v29
    v_lshl_or_b32 v31, v31, 5, v29
    s_add_u32 s11, s8, 0
    s_and_b32 s11, s11, 3
    s_and_b32 s12, s11, 1
    s_lshl_b32 s12, s12, 6
    s_lshl_b32 s13, s11, 13
    v_xor_b32 v29, s12, v28
    v_add_u32 v2, s13, v29
    s_add_u32 s11, s7, 0
    s_and_b32 s11, s11, 3
    s_and_b32 s12, s11, 1
    s_lshl_b32 s12, s12, 5
    s_lshr_b32 s13, s11, 1
    s_mul_i32 s13, s13, 14336
    v_xor_b32 v29, s12, v31
    v_add3_u32 v6, v29, v30, s13
    s_add_u32 s11, s8, 1
    s_and_b32 s11, s11, 3
    s_and_b32 s12, s11, 1
    s_lshl_b32 s12, s12, 6
    s_lshl_b32 s13, s11, 13
    v_xor_b32 v29, s12, v28
    v_add_u32 v3, s13, v29
    s_add_u32 s11, s7, 1
    s_and_b32 s11, s11, 3
    s_and_b32 s12, s11, 1
    s_lshl_b32 s12, s12, 5
    s_lshr_b32 s13, s11, 1
    s_mul_i32 s13, s13, 14336
    v_xor_b32 v29, s12, v31
    v_add3_u32 v7, v29, v30, s13
    s_add_u32 s11, s8, 2
    s_and_b32 s11, s11, 3
    s_and_b32 s12, s11, 1
    s_lshl_b32 s12, s12, 6
    s_lshl_b32 s13, s11, 13
    v_xor_b32 v29, s12, v28
    v_add_u32 v4, s13, v29
    s_add_u32 s11, s7, 2
    s_and_b32 s11, s11, 3
    s_and_b32 s12, s11, 1
    s_lshl_b32 s12, s12, 5
    s_lshr_b32 s13, s11, 1
    s_mul_i32 s13, s13, 14336
    v_xor_b32 v29, s12, v31
    v_add3_u32 v8, v29, v30, s13
    s_add_u32 s11, s8, 3
    s_and_b32 s11, s11, 3
    s_and_b32 s12, s11, 1
    s_lshl_b32 s12, s12, 6
    s_lshl_b32 s13, s11, 13
    v_xor_b32 v29, s12, v28
    v_add_u32 v5, s13, v29
    s_add_u32 s11, s7, 3
    s_and_b32 s11, s11, 3
    s_and_b32 s12, s11, 1
    s_lshl_b32 s12, s12, 5
    s_lshr_b32 s13, s11, 1
    s_mul_i32 s13, s13, 14336
    v_xor_b32 v29, s12, v31
    v_add3_u32 v9, v29, v30, s13
    s_lshl_b32 s94, s90, 7
    s_add_u32 s94, s94, s91
    s_mul_i32 s93, s90, 229376
    s_add_u32 s93, s93, s92
    s_and_b32 s11, s88, 1
    s_lshr_b32 s12, s88, 1
    s_lshl_b32 s13, s9, 1
    s_add_u32 s13, s13, s11
    s_mul_i32 s14, s13, 112
    s_lshl_b32 s15, s10, 3
    s_add_u32 s14, s14, s15
    s_lshl_b32 s15, s12, 2
    s_add_u32 s14, s14, s15
    s_lshl_b32 s95, s14, 11
    s_mul_i32 s13, s13, 28
    s_lshl_b32 s14, s10, 1
    s_add_u32 s13, s13, s14
    s_add_u32 s13, s13, s12
    s_lshl_b32 s13, s13, 7
    s_add_u32 s13, s13, 13893632
    s_waitcnt lgkmcnt(0)
    s_mov_b64 s[44:45], s[16:17]
    s_mov_b32 s46, 2097152
    s_mov_b32 s47, 0x20000
    s_and_b32 s11, s7, 1
    s_cmp_eq_u32 s11, 0
    s_cselect_b64 s[48:49], s[30:31], s[32:33]
    s_cselect_b64 s[52:53], s[32:33], s[30:31]
    s_mov_b32 s50, 1835008
    s_mov_b32 s51, 0x20000
    s_mov_b32 s54, 1835008
    s_mov_b32 s55, 0x20000
    s_add_u32 s11, s7, 0
    s_and_b32 s11, s11, 3
    s_lshl_b32 s11, s11, 10
    s_add_u32 s16, s11, s89
    s_add_u32 s11, s8, 0
    s_and_b32 s11, s11, 3
    s_lshl_b32 s11, s11, 10
    s_add_u32 s20, s11, s89
    s_add_u32 s11, s7, 1
    s_and_b32 s11, s11, 3
    s_lshl_b32 s11, s11, 10
    s_add_u32 s17, s11, s89
    s_add_u32 s11, s8, 1
    s_and_b32 s11, s11, 3
    s_lshl_b32 s11, s11, 10
    s_add_u32 s21, s11, s89
    s_add_u32 s11, s7, 2
    s_and_b32 s11, s11, 3
    s_lshl_b32 s11, s11, 10
    s_add_u32 s18, s11, s89
    s_add_u32 s11, s8, 2
    s_and_b32 s11, s11, 3
    s_lshl_b32 s11, s11, 10
    s_add_u32 s22, s11, s89
    s_add_u32 s11, s7, 3
    s_and_b32 s11, s11, 3
    s_lshl_b32 s11, s11, 10
    s_add_u32 s19, s11, s89
    s_add_u32 s11, s8, 3
    s_and_b32 s11, s11, 3
    s_lshl_b32 s11, s11, 10
    s_add_u32 s23, s11, s89
    s_add_u32 m0, s20, 81920
    s_nop 0
    buffer_load_dwordx4 v2, s[44:47], s94 offen  lds
    s_add_u32 m0, s21, 81920
    s_nop 0
    buffer_load_dwordx4 v3, s[44:47], s94 offen  lds
    s_add_u32 m0, s22, 81920
    s_nop 0
    buffer_load_dwordx4 v4, s[44:47], s94 offen  lds
    s_add_u32 m0, s23, 81920
    s_nop 0
    buffer_load_dwordx4 v5, s[44:47], s94 offen  lds
    s_add_u32 m0, s16, 16384
    s_nop 0
    buffer_load_dwordx4 v6, s[48:51], s93 offen  lds
    s_add_u32 m0, s17, 16384
    s_nop 0
    buffer_load_dwordx4 v7, s[52:55], s93 offen  lds
    s_add_u32 m0, s18, 16384
    s_nop 0
    buffer_load_dwordx4 v8, s[48:51], s93 offen  lds
    s_add_u32 m0, s19, 16384
    s_nop 0
    buffer_load_dwordx4 v9, s[52:55], s93 offen  lds
    s_add_u32 s93, s90, 0
    s_and_b32 s93, s93, 7
    s_mul_i32 s93, s93, 229376
    s_add_u32 s93, s93, s92
    s_add_u32 s93, s93, 114688
    s_add_u32 m0, s16, 32768
    s_nop 0
    buffer_load_dwordx4 v6, s[48:51], s93 offen  lds
    s_add_u32 m0, s17, 32768
    s_nop 0
    buffer_load_dwordx4 v7, s[52:55], s93 offen  lds
    s_add_u32 m0, s18, 32768
    s_nop 0
    buffer_load_dwordx4 v8, s[48:51], s93 offen  lds
    s_add_u32 m0, s19, 32768
    s_nop 0
    buffer_load_dwordx4 v9, s[52:55], s93 offen  lds
    s_cmp_lg_u32 s88, 3
    s_cbranch_scc1 L_pf_1
    s_getpc_b64 s[6:7]
L_pc_2:
    s_sub_u32 s6, s6, L_pc_2-gated_mix__ssm_conv_h3__glu_gated_reglu__prompt_kernel
    s_subb_u32 s7, s7, 0
    s_lshr_b32 s3, s2, 3
    s_and_b32 s3, s3, 7
    s_mul_i32 s3, s3, 5120
    v_min_u32 v28, 39, v0
    v_lshlrev_b32 v28, 7, v28
    v_add_u32 v28, s3, v28
    v_min_u32 v28, L_codeend-gated_mix__ssm_conv_h3__glu_gated_reglu__prompt_kernel-4, v28
    global_load_dword v127, v28, s[6:7]
L_pf_1:
    s_add_u32 s4, s90, 1
    s_and_b32 s4, s4, 7
    s_lshl_b32 s4, s4, 7
    s_add_u32 s4, s4, s91
    s_add_u32 m0, s20, 98304
    s_nop 0
    buffer_load_dwordx4 v2, s[44:47], s4 offen  lds
    s_add_u32 s3, s90, 1
    s_and_b32 s3, s3, 7
    s_mul_i32 s3, s3, 229376
    s_add_u32 s3, s3, s92
    s_add_u32 m0, s16, 49152
    s_nop 0
    buffer_load_dwordx4 v6, s[48:51], s3 offen  lds
    s_add_u32 s3, s90, 1
    s_and_b32 s3, s3, 7
    s_mul_i32 s3, s3, 229376
    s_add_u32 s3, s3, s92
    s_add_u32 s3, s3, 114688
    s_add_u32 m0, s16, 65536
    s_nop 0
    buffer_load_dwordx4 v6, s[48:51], s3 offen  lds
    s_lshr_b32 s3, s88, 1
    s_lshl_b32 s3, s3, 2
    v_bfe_u32 v28, v0, 2, 2
    v_bfe_u32 v29, v0, 1, 1
    v_lshl_or_b32 v30, v28, 1, v29
    v_lshlrev_b32 v28, 8, v28
    v_lshl_or_b32 v28, v29, 10, v28
    v_lshrrev_b32 v29, 5, v0
    v_lshl_or_b32 v28, v29, 12, v28
    v_bfe_u32 v29, v0, 4, 1
    v_lshl_or_b32 v28, v29, 4, v28
    v_and_b32 v29, 1, v0
    v_lshl_or_b32 v28, v29, 3, v28
    v_xor_b32 v30, s3, v30
    v_xor_b32 v29, 0, v30
    v_lshl_or_b32 v10, v29, 5, v28
    v_xor_b32 v29, 1, v30
    v_lshl_or_b32 v11, v29, 5, v28
    v_xor_b32 v29, 2, v30
    v_lshl_or_b32 v12, v29, 5, v28
    v_xor_b32 v29, 3, v30
    v_lshl_or_b32 v13, v29, 5, v28
    s_and_b32 s3, s88, 1
    s_lshl_b32 s3, s3, 13
    s_add_u32 s3, s3, 81920
    v_and_b32 v28, 31, v0
    v_lshlrev_b32 v28, 7, v28
    v_add_u32 v28, s3, v28
    v_bfe_u32 v29, v0, 1, 3
    v_lshrrev_b32 v30, 5, v0
    v_xor_b32 v29, v29, v30
    v_xor_b32 v30, 0, v29
    v_lshl_add_u32 v14, v30, 4, v28
    v_xor_b32 v30, 2, v29
    v_lshl_add_u32 v15, v30, 4, v28
    v_xor_b32 v30, 4, v29
    v_lshl_add_u32 v16, v30, 4, v28
    v_xor_b32 v30, 6, v29
    v_lshl_add_u32 v17, v30, 4, v28
    s_mov_b64 s[60:61], s[42:43]
    s_mov_b32 s62, 14680064
    s_mov_b32 s63, 0x20000
    s_waitcnt vmcnt(7)
    s_barrier
    ds_read_b128 v[48:51], v14 offset:0
    ds_read_b64_tr_b16 v[32:33], v10 offset:16384
    ds_read_b64_tr_b16 v[34:35], v10 offset:18432
    ds_read_b128 v[52:55], v14 offset:4096
    ds_read_b64_tr_b16 v[36:37], v11 offset:16384
    ds_read_b64_tr_b16 v[38:39], v11 offset:18432
    ds_read_b64_tr_b16 v[40:41], v12 offset:16384
    ds_read_b64_tr_b16 v[42:43], v12 offset:18432
    ds_read_b64_tr_b16 v[44:45], v13 offset:16384
    ds_read_b64_tr_b16 v[46:47], v13 offset:18432
    s_waitcnt lgkmcnt(7)
    v_mfma_f32_32x32x16_bf16 v[128:143], v[32:35], v[48:51], 0
    ds_read_b128 v[72:75], v15 offset:0
    ds_read_b64_tr_b16 v[56:57], v10 offset:24576
    s_add_u32 s94, s90, 1
    s_and_b32 s94, s94, 7
    s_lshl_b32 s94, s94, 7
    s_waitcnt lgkmcnt(8)
    v_mfma_f32_32x32x16_bf16 v[144:159], v[32:35], v[52:55], 0
    ds_read_b64_tr_b16 v[58:59], v10 offset:26624
    ds_read_b128 v[76:79], v15 offset:4096
    s_add_u32 s94, s94, s91
    s_add_u32 m0, s21, 98304
    s_nop 0
    buffer_load_dwordx4 v3, s[44:47], s94 offen  lds
    s_waitcnt lgkmcnt(8)
    v_mfma_f32_32x32x16_bf16 v[160:175], v[36:39], v[48:51], 0
    ds_read_b64_tr_b16 v[60:61], v11 offset:24576
    ds_read_b64_tr_b16 v[62:63], v11 offset:26624
    s_add_u32 m0, s22, 98304
    s_nop 0
    buffer_load_dwordx4 v4, s[44:47], s94 offen  lds
    s_lshr_b32 s5, s2, 3
    s_lshl_b32 s5, s5, 2
    s_add_u32 s5, s5, s88
    s_mul_i32 s5, s5, 14
    v_min_u32 v28, 13, v0
    v_mfma_f32_32x32x16_bf16 v[176:191], v[36:39], v[52:55], 0
    ds_read_b64_tr_b16 v[64:65], v12 offset:24576
    ds_read_b64_tr_b16 v[66:67], v12 offset:26624
    s_add_u32 m0, s23, 98304
    s_nop 0
    buffer_load_dwordx4 v5, s[44:47], s94 offen  lds
    s_add_u32 s93, s90, 1
    v_add_u32 v28, s5, v28
    v_lshlrev_b32 v28, 10, v28
    v_add_u32 v28, 384, v28
    s_waitcnt lgkmcnt(10)
    v_mfma_f32_32x32x16_bf16 v[192:207], v[40:43], v[48:51], 0
    ds_read_b64_tr_b16 v[68:69], v13 offset:24576
    ds_read_b64_tr_b16 v[70:71], v13 offset:26624
    s_and_b32 s93, s93, 7
    s_mul_i32 s93, s93, 229376
    s_add_u32 s93, s93, s92
    global_load_dword v126, v28, s[34:35]
    s_lshr_b32 s5, s2, 5
    s_mul_i32 s5, s5, 3
    s_and_b32 s5, s5, 7
    v_mfma_f32_32x32x16_bf16 v[208:223], v[40:43], v[52:55], 0
    s_add_u32 m0, s17, 49152
    s_nop 0
    buffer_load_dwordx4 v7, s[52:55], s93 offen  lds
    s_add_u32 m0, s18, 49152
    s_nop 0
    buffer_load_dwordx4 v8, s[48:51], s93 offen  lds
    s_cmp_lt_u32 s5, 2
    s_cselect_b32 s5, 0, 0
    s_xor_b32 s89, s2, s5
    s_mov_b64 s[56:57], s[42:43]
    s_mov_b32 s58, 14680064
    s_waitcnt lgkmcnt(10)
    v_mfma_f32_32x32x16_bf16 v[224:239], v[44:47], v[48:51], 0
    s_add_u32 m0, s19, 49152
    s_nop 0
    buffer_load_dwordx4 v9, s[52:55], s93 offen  lds
    s_add_u32 s3, s90, 2
    s_and_b32 s3, s3, 7
    s_mul_i32 s3, s3, 229376
    s_mov_b32 s59, 0x20000
    s_lshr_b32 s5, s88, 1
    s_lshl_b32 s6, s89, 1
    s_add_u32 s5, s5, s6
    v_mfma_f32_32x32x16_bf16 v[240:255], v[44:47], v[52:55], 0
    s_add_u32 s3, s3, s92
    s_lshl_b32 s6, s5, 12
    s_add_u32 s64, s24, s6
    s_addc_u32 s65, s25, 0
    s_mov_b32 s66, 4096
    s_mov_b32 s67, 0x20000
    s_waitcnt lgkmcnt(0)
    s_waitcnt vmcnt(10)
    s_barrier
    v_mfma_f32_32x32x16_bf16 v[128:143], v[56:59], v[72:75], v[128:143]
    ds_read_b128 v[48:51], v16 offset:0
    ds_read_b64_tr_b16 v[32:33], v10 offset:32768
    s_add_u32 m0, s16, 0
    s_nop 0
    buffer_load_dwordx4 v6, s[48:51], s3 offen  lds
    s_add_u32 s4, s90, 2
    s_lshl_b32 s6, s89, 2
    v_mov_b32 v28, s6
    global_load_dword v19, v28, s[26:27]
    v_mfma_f32_32x32x16_bf16 v[144:159], v[56:59], v[76:79], v[144:159]
    ds_read_b64_tr_b16 v[34:35], v10 offset:34816
    ds_read_b128 v[52:55], v16 offset:4096
    s_and_b32 s4, s4, 7
    s_lshl_b32 s4, s4, 7
    s_add_u32 s4, s4, s91
    s_mov_b32 s7, 0
    s_mul_i32 s8, s98, 7
    s_add_u32 s8, s8, 2
    s_lshr_b32 s7, s8, 2
    v_mfma_f32_32x32x16_bf16 v[160:175], v[60:63], v[72:75], v[160:175]
    ds_read_b64_tr_b16 v[36:37], v11 offset:32768
    ds_read_b64_tr_b16 v[38:39], v11 offset:34816
    s_add_u32 m0, s20, 114688
    s_nop 0
    buffer_load_dwordx4 v2, s[44:47], s4 offen  lds
    s_add_u32 s93, s90, 1
    s_and_b32 s8, s2, 7
    s_mul_i32 s8, s8, 7
    s_lshr_b32 s8, s8, 2
    s_add_u32 s7, s7, s8
    v_mfma_f32_32x32x16_bf16 v[176:191], v[60:63], v[76:79], v[176:191]
    ds_read_b64_tr_b16 v[40:41], v12 offset:32768
    ds_read_b64_tr_b16 v[42:43], v12 offset:34816
    s_and_b32 s93, s93, 7
    s_mul_i32 s93, s93, 229376
    s_add_u32 s93, s93, s92
    s_sub_u32 s8, s7, 14
    s_cmp_ge_u32 s7, 14
    s_cselect_b32 s7, s8, s7
    s_mul_i32 s8, s88, 57344
    v_mfma_f32_32x32x16_bf16 v[192:207], v[64:67], v[72:75], v[192:207]
    ds_read_b64_tr_b16 v[44:45], v13 offset:32768
    ds_read_b64_tr_b16 v[46:47], v13 offset:34816
    s_add_u32 s93, s93, 114688
    s_add_u32 m0, s17, 65536
    s_nop 0
    buffer_load_dwordx4 v7, s[52:55], s93 offen  lds
    s_lshl_b32 s7, s7, 12
    s_add_u32 s9, s8, 57344
    s_add_u32 s74, s7, s8
    s_add_u32 s75, s74, 4096
    v_mfma_f32_32x32x16_bf16 v[208:223], v[64:67], v[76:79], v[208:223]
    s_add_u32 m0, s18, 65536
    s_nop 0
    buffer_load_dwordx4 v8, s[48:51], s93 offen  lds
    s_add_u32 m0, s19, 65536
    s_nop 0
    buffer_load_dwordx4 v9, s[52:55], s93 offen  lds
    s_add_u32 s3, s90, 2
    s_cmp_eq_u32 s75, s9
    s_cselect_b32 s75, s8, s75
    s_add_u32 s76, s75, 4096
    v_mfma_f32_32x32x16_bf16 v[224:239], v[68:71], v[72:75], v[224:239]
    s_and_b32 s3, s3, 7
    s_mul_i32 s3, s3, 229376
    s_add_u32 s3, s3, s92
    s_add_u32 s3, s3, 114688
    s_cmp_eq_u32 s76, s9
    s_cselect_b32 s76, s8, s76
    s_add_u32 s77, s76, 4096
    s_cmp_eq_u32 s77, s9
    s_cselect_b32 s77, s8, s77
    v_mfma_f32_32x32x16_bf16 v[240:255], v[68:71], v[76:79], v[240:255]
    s_add_u32 m0, s16, 16384
    s_nop 0
    buffer_load_dwordx4 v6, s[48:51], s3 offen  lds
    s_add_u32 s78, s77, 4096
    s_cmp_eq_u32 s78, s9
    s_cselect_b32 s78, s8, s78
    s_add_u32 s79, s78, 4096
    s_cmp_eq_u32 s79, s9
    s_cselect_b32 s79, s8, s79
    s_add_u32 s80, s79, 4096
    s_waitcnt lgkmcnt(7)
    v_mfma_f32_32x32x16_bf16 v[128:143], v[32:35], v[48:51], v[128:143]
    ds_read_b128 v[72:75], v17 offset:0
    ds_read_b64_tr_b16 v[56:57], v10 offset:40960
    s_cmp_eq_u32 s80, s9
    s_cselect_b32 s80, s8, s80
    s_add_u32 s81, s80, 4096
    s_cmp_eq_u32 s81, s9
    s_cselect_b32 s81, s8, s81
    s_add_u32 s82, s81, 4096
    s_waitcnt lgkmcnt(8)
    v_mfma_f32_32x32x16_bf16 v[144:159], v[32:35], v[52:55], v[144:159]
    ds_read_b64_tr_b16 v[58:59], v10 offset:43008
    ds_read_b128 v[76:79], v17 offset:4096
    s_cmp_eq_u32 s82, s9
    s_cselect_b32 s82, s8, s82
    s_add_u32 s83, s82, 4096
    s_cmp_eq_u32 s83, s9
    s_cselect_b32 s83, s8, s83
    s_add_u32 s84, s83, 4096
    s_waitcnt lgkmcnt(8)
    v_mfma_f32_32x32x16_bf16 v[160:175], v[36:39], v[48:51], v[160:175]
    ds_read_b64_tr_b16 v[60:61], v11 offset:40960
    ds_read_b64_tr_b16 v[62:63], v11 offset:43008
    s_cmp_eq_u32 s84, s9
    s_cselect_b32 s84, s8, s84
    s_add_u32 s85, s84, 4096
    s_cmp_eq_u32 s85, s9
    s_cselect_b32 s85, s8, s85
    s_add_u32 s86, s85, 4096
    v_mfma_f32_32x32x16_bf16 v[176:191], v[36:39], v[52:55], v[176:191]
    ds_read_b64_tr_b16 v[64:65], v12 offset:40960
    ds_read_b64_tr_b16 v[66:67], v12 offset:43008
    s_cmp_eq_u32 s86, s9
    s_cselect_b32 s86, s8, s86
    s_add_u32 s87, s86, 4096
    s_cmp_eq_u32 s87, s9
    s_cselect_b32 s87, s8, s87
    s_mov_b64 s[68:69], s[34:35]
    s_mov_b32 s70, 1835008
    s_waitcnt lgkmcnt(10)
    v_mfma_f32_32x32x16_bf16 v[192:207], v[40:43], v[48:51], v[192:207]
    ds_read_b64_tr_b16 v[68:69], v13 offset:40960
    ds_read_b64_tr_b16 v[70:71], v13 offset:43008
    s_mov_b32 s71, 0x20000
    v_lshrrev_b32 v28, 3, v0
    v_bfe_u32 v29, v0, 4, 1
    v_lshlrev_b32 v29, 2, v29
    v_and_b32 v30, 7, v0
    v_xor_b32 v29, v29, v30
    v_lshlrev_b32 v28, 10, v28
    v_mfma_f32_32x32x16_bf16 v[208:223], v[40:43], v[52:55], v[208:223]
    v_lshl_add_u32 v28, v29, 4, v28
    s_lshl_b32 s5, s98, 7
    v_add_u32 v22, s5, v28
    s_lshl_b32 s5, s88, 13
    s_add_u32 s29, s5, 98304
    v_lshrrev_b32 v28, 5, v0
    v_bfe_u32 v29, v0, 2, 2
    v_lshl_or_b32 v28, v28, 2, v29
    v_lshlrev_b32 v28, 7, v28
    s_waitcnt lgkmcnt(10)
    v_mfma_f32_32x32x16_bf16 v[224:239], v[44:47], v[48:51], v[224:239]
    v_add_u32 v28, s29, v28
    v_and_b32 v29, 1, v0
    v_lshl_add_u32 v28, v29, 3, v28
    v_bfe_u32 v29, v0, 4, 1
    v_bfe_u32 v30, v0, 1, 1
    v_lshl_or_b32 v29, v29, 1, v30
    v_bfe_u32 v30, v0, 3, 1
    v_lshl_or_b32 v29, v30, 2, v29
    v_mfma_f32_32x32x16_bf16 v[240:255], v[44:47], v[52:55], v[240:255]
    s_and_b32 s5, s88, 1
    s_lshl_b32 s5, s5, 2
    s_and_b32 s6, s88, 2
    s_or_b32 s5, s5, s6
    v_xor_b32 v29, s5, v29
    v_lshl_add_u32 v20, v29, 4, v28
    s_waitcnt lgkmcnt(0)
    s_waitcnt vmcnt(7)
    s_barrier
    v_mfma_f32_32x32x16_bf16 v[128:143], v[56:59], v[72:75], v[128:143]
    ds_read_b128 v[48:51], v14 offset:16384
    ds_read_b64_tr_b16 v[32:33], v10 offset:49152
    s_add_u32 s94, s90, 2
    s_and_b32 s94, s94, 7
    s_lshl_b32 s94, s94, 7
    v_xor_b32 v29, 4, v29
    v_lshl_add_u32 v21, v29, 4, v28
    v_mfma_f32_32x32x16_bf16 v[144:159], v[56:59], v[76:79], v[144:159]
    ds_read_b64_tr_b16 v[34:35], v10 offset:51200
    ds_read_b128 v[52:55], v14 offset:20480
    s_add_u32 s94, s94, s91
    s_add_u32 m0, s21, 114688
    s_nop 0
    buffer_load_dwordx4 v3, s[44:47], s94 offen  lds
    v_mfma_f32_32x32x16_bf16 v[160:175], v[60:63], v[72:75], v[160:175]
    ds_read_b64_tr_b16 v[36:37], v11 offset:49152
    ds_read_b64_tr_b16 v[38:39], v11 offset:51200
    s_add_u32 m0, s22, 114688
    s_nop 0
    buffer_load_dwordx4 v4, s[44:47], s94 offen  lds
    v_mfma_f32_32x32x16_bf16 v[176:191], v[60:63], v[76:79], v[176:191]
    ds_read_b64_tr_b16 v[40:41], v12 offset:49152
    ds_read_b64_tr_b16 v[42:43], v12 offset:51200
    s_add_u32 m0, s23, 114688
    s_nop 0
    buffer_load_dwordx4 v5, s[44:47], s94 offen  lds
    s_add_u32 s93, s90, 2
    v_mfma_f32_32x32x16_bf16 v[192:207], v[64:67], v[72:75], v[192:207]
    ds_read_b64_tr_b16 v[44:45], v13 offset:49152
    ds_read_b64_tr_b16 v[46:47], v13 offset:51200
    s_and_b32 s93, s93, 7
    s_mul_i32 s93, s93, 229376
    s_add_u32 s93, s93, s92
    v_mfma_f32_32x32x16_bf16 v[208:223], v[64:67], v[76:79], v[208:223]
    s_add_u32 m0, s17, 0
    s_nop 0
    buffer_load_dwordx4 v7, s[52:55], s93 offen  lds
    s_add_u32 m0, s18, 0
    s_nop 0
    buffer_load_dwordx4 v8, s[48:51], s93 offen  lds
    v_mfma_f32_32x32x16_bf16 v[224:239], v[68:71], v[72:75], v[224:239]
    s_add_u32 m0, s19, 0
    s_nop 0
    buffer_load_dwordx4 v9, s[52:55], s93 offen  lds
    s_add_u32 s3, s90, 3
    s_and_b32 s3, s3, 7
    s_mul_i32 s3, s3, 229376
    v_mfma_f32_32x32x16_bf16 v[240:255], v[68:71], v[76:79], v[240:255]
    s_add_u32 s3, s3, s92
    s_add_u32 m0, s16, 32768
    s_nop 0
    buffer_load_dwordx4 v6, s[48:51], s3 offen  lds
    s_add_u32 s4, s90, 3
    s_and_b32 s4, s4, 7
    s_waitcnt lgkmcnt(7)
    v_mfma_f32_32x32x16_bf16 v[128:143], v[32:35], v[48:51], v[128:143]
    ds_read_b128 v[72:75], v15 offset:16384
    ds_read_b64_tr_b16 v[56:57], v10 offset:57344
    s_lshl_b32 s4, s4, 7
    s_add_u32 s4, s4, s91
    s_waitcnt lgkmcnt(8)
    v_mfma_f32_32x32x16_bf16 v[144:159], v[32:35], v[52:55], v[144:159]
    ds_read_b64_tr_b16 v[58:59], v10 offset:59392
    ds_read_b128 v[76:79], v15 offset:20480
    s_add_u32 m0, s20, 81920
    s_nop 0
    buffer_load_dwordx4 v2, s[44:47], s4 offen  lds
    s_waitcnt lgkmcnt(8)
    v_mfma_f32_32x32x16_bf16 v[160:175], v[36:39], v[48:51], v[160:175]
    ds_read_b64_tr_b16 v[60:61], v11 offset:57344
    ds_read_b64_tr_b16 v[62:63], v11 offset:59392
    v_mfma_f32_32x32x16_bf16 v[176:191], v[36:39], v[52:55], v[176:191]
    ds_read_b64_tr_b16 v[64:65], v12 offset:57344
    ds_read_b64_tr_b16 v[66:67], v12 offset:59392
    s_waitcnt lgkmcnt(10)
    v_mfma_f32_32x32x16_bf16 v[192:207], v[40:43], v[48:51], v[192:207]
    ds_read_b64_tr_b16 v[68:69], v13 offset:57344
    ds_read_b64_tr_b16 v[70:71], v13 offset:59392
    v_mfma_f32_32x32x16_bf16 v[208:223], v[40:43], v[52:55], v[208:223]
    s_and_b32 s6, s88, 1
    s_mul_i32 s6, s6, 2048
    s_sub_u32 s6, s6, 128
    v_add_u32 v30, s6, v1
    v_add_u32 v31, 16, v30
    s_waitcnt lgkmcnt(10)
    v_mfma_f32_32x32x16_bf16 v[224:239], v[44:47], v[48:51], v[224:239]
    v_add_u32 v29, 1024, v30
    v_cmp_gt_i32 vcc, 0, v30
    v_bfrev_b32 v28, 1
    s_nop 0
    v_cndmask_b32 v30, v30, v28, vcc
    v_mfma_f32_32x32x16_bf16 v[240:255], v[44:47], v[52:55], v[240:255]
    v_cmp_gt_i32 vcc, 0, v31
    s_nop 1
    v_cndmask_b32 v31, v31, v28, vcc
    s_waitcnt lgkmcnt(0)
    s_waitcnt vmcnt(9)
    s_barrier
    v_mfma_f32_32x32x16_bf16 v[128:143], v[56:59], v[72:75], v[128:143]
    ds_read_b128 v[48:51], v16 offset:16384
    v_add_u32 v10, 0x10000, v10
    s_add_u32 s93, s90, 2
    s_and_b32 s93, s93, 7
    s_mul_i32 s93, s93, 229376
    v_mfma_f32_32x32x16_bf16 v[144:159], v[56:59], v[76:79], v[144:159]
    v_add_u32 v11, 0x10000, v11
    v_add_u32 v12, 0x10000, v12
    s_add_u32 s93, s93, s92
    s_add_u32 s93, s93, 114688
    buffer_load_dwordx4 v[80:83], v30, s[64:67], 0 offen nt
    v_mfma_f32_32x32x16_bf16 v[160:175], v[60:63], v[72:75], v[160:175]
    v_add_u32 v13, 0x10000, v13
    ds_read_b64_tr_b16 v[32:33], v10 offset:0
    s_add_u32 m0, s17, 16384
    s_nop 0
    buffer_load_dwordx4 v7, s[52:55], s93 offen  lds
    v_mfma_f32_32x32x16_bf16 v[176:191], v[60:63], v[76:79], v[176:191]
    ds_read_b64_tr_b16 v[34:35], v10 offset:2048
    ds_read_b128 v[52:55], v16 offset:20480
    s_add_u32 m0, s18, 16384
    s_nop 0
    buffer_load_dwordx4 v8, s[48:51], s93 offen  lds
    v_mfma_f32_32x32x16_bf16 v[192:207], v[64:67], v[72:75], v[192:207]
    ds_read_b64_tr_b16 v[36:37], v11 offset:0
    ds_read_b64_tr_b16 v[38:39], v11 offset:2048
    s_add_u32 m0, s19, 16384
    s_nop 0
    buffer_load_dwordx4 v9, s[52:55], s93 offen  lds
    s_add_u32 s3, s90, 3
    v_mfma_f32_32x32x16_bf16 v[208:223], v[64:67], v[76:79], v[208:223]
    ds_read_b64_tr_b16 v[40:41], v12 offset:0
    ds_read_b64_tr_b16 v[42:43], v12 offset:2048
    s_and_b32 s3, s3, 7
    s_mul_i32 s3, s3, 229376
    s_add_u32 s3, s3, s92
    v_mfma_f32_32x32x16_bf16 v[224:239], v[68:71], v[72:75], v[224:239]
    ds_read_b64_tr_b16 v[44:45], v13 offset:0
    ds_read_b64_tr_b16 v[46:47], v13 offset:2048
    s_add_u32 s3, s3, 114688
    s_add_u32 m0, s16, 49152
    s_nop 0
    buffer_load_dwordx4 v6, s[48:51], s3 offen  lds
    v_mfma_f32_32x32x16_bf16 v[240:255], v[68:71], v[76:79], v[240:255]
    buffer_load_dwordx2 v[84:85], v31, s[64:67], 0 offen nt
    buffer_load_dwordx4 v[86:89], v29, s[64:67], 0 offen nt
    buffer_load_dwordx2 v[90:91], v29, s[64:67], 0 offen offset:16 nt
    buffer_load_dwordx4 v[92:95], v29, s[64:67], 0 offen offset:1024 nt
    s_waitcnt lgkmcnt(7)
    v_mfma_f32_32x32x16_bf16 v[128:143], v[32:35], v[48:51], v[128:143]
    ds_read_b128 v[72:75], v17 offset:16384
    ds_read_b64_tr_b16 v[56:57], v10 offset:8192
    buffer_load_dwordx2 v[96:97], v29, s[64:67], 0 offen offset:1040 nt
    s_waitcnt lgkmcnt(8)
    v_mfma_f32_32x32x16_bf16 v[144:159], v[32:35], v[52:55], v[144:159]
    ds_read_b64_tr_b16 v[58:59], v10 offset:10240
    ds_read_b128 v[76:79], v17 offset:20480
    s_waitcnt lgkmcnt(8)
    v_mfma_f32_32x32x16_bf16 v[160:175], v[36:39], v[48:51], v[160:175]
    ds_read_b64_tr_b16 v[60:61], v11 offset:8192
    ds_read_b64_tr_b16 v[62:63], v11 offset:10240
    s_lshl_b32 s96, s74, 3
    s_add_u32 m0, s29, 32768
    s_nop 0
    buffer_load_dwordx4 v22, s[68:71], s96 offen offset:0  lds
    s_add_u32 s96, s96, 7168
    buffer_load_dwordx4 v22, s[68:71], s96 offen offset:1024  lds
    v_mfma_f32_32x32x16_bf16 v[176:191], v[36:39], v[52:55], v[176:191]
    ds_read_b64_tr_b16 v[64:65], v12 offset:8192
    ds_read_b64_tr_b16 v[66:67], v12 offset:10240
    s_waitcnt lgkmcnt(10)
    v_mfma_f32_32x32x16_bf16 v[192:207], v[40:43], v[48:51], v[192:207]
    ds_read_b64_tr_b16 v[68:69], v13 offset:8192
    ds_read_b64_tr_b16 v[70:71], v13 offset:10240
    v_mfma_f32_32x32x16_bf16 v[208:223], v[40:43], v[52:55], v[208:223]
    s_waitcnt lgkmcnt(10)
    v_mfma_f32_32x32x16_bf16 v[224:239], v[44:47], v[48:51], v[224:239]
    v_mfma_f32_32x32x16_bf16 v[240:255], v[44:47], v[52:55], v[240:255]
    s_waitcnt lgkmcnt(0)
    s_waitcnt vmcnt(14)
    s_barrier
    v_mfma_f32_32x32x16_bf16 v[128:143], v[56:59], v[72:75], v[128:143]
    ds_read_b128 v[48:51], v14 offset:32768
    v_subrev_u32 v10, 0x10000, v10
    s_add_u32 s94, s90, 3
    s_and_b32 s94, s94, 7
    s_lshl_b32 s94, s94, 7
    v_mfma_f32_32x32x16_bf16 v[144:159], v[56:59], v[76:79], v[144:159]
    v_subrev_u32 v11, 0x10000, v11
    v_subrev_u32 v12, 0x10000, v12
    s_add_u32 s94, s94, s91
    s_add_u32 m0, s21, 81920
    s_nop 0
    buffer_load_dwordx4 v3, s[44:47], s94 offen  lds
    v_mfma_f32_32x32x16_bf16 v[160:175], v[60:63], v[72:75], v[160:175]
    v_subrev_u32 v13, 0x10000, v13
    ds_read_b64_tr_b16 v[32:33], v10 offset:0
    s_add_u32 m0, s22, 81920
    s_nop 0
    buffer_load_dwordx4 v4, s[44:47], s94 offen  lds
    v_mfma_f32_32x32x16_bf16 v[176:191], v[60:63], v[76:79], v[176:191]
    ds_read_b64_tr_b16 v[34:35], v10 offset:2048
    ds_read_b128 v[52:55], v14 offset:36864
    s_add_u32 m0, s23, 81920
    s_nop 0
    buffer_load_dwordx4 v5, s[44:47], s94 offen  lds
    s_add_u32 s93, s90, 3
    v_mfma_f32_32x32x16_bf16 v[192:207], v[64:67], v[72:75], v[192:207]
    ds_read_b64_tr_b16 v[36:37], v11 offset:0
    ds_read_b64_tr_b16 v[38:39], v11 offset:2048
    s_and_b32 s93, s93, 7
    s_mul_i32 s93, s93, 229376
    s_add_u32 s93, s93, s92
    v_mfma_f32_32x32x16_bf16 v[208:223], v[64:67], v[76:79], v[208:223]
    ds_read_b64_tr_b16 v[40:41], v12 offset:0
    ds_read_b64_tr_b16 v[42:43], v12 offset:2048
    s_add_u32 m0, s17, 32768
    s_nop 0
    buffer_load_dwordx4 v7, s[52:55], s93 offen  lds
    v_mfma_f32_32x32x16_bf16 v[224:239], v[68:71], v[72:75], v[224:239]
    ds_read_b64_tr_b16 v[44:45], v13 offset:0
    ds_read_b64_tr_b16 v[46:47], v13 offset:2048
    s_add_u32 m0, s18, 32768
    s_nop 0
    buffer_load_dwordx4 v8, s[48:51], s93 offen  lds
    v_mfma_f32_32x32x16_bf16 v[240:255], v[68:71], v[76:79], v[240:255]
    s_add_u32 m0, s19, 32768
    s_nop 0
    buffer_load_dwordx4 v9, s[52:55], s93 offen  lds
    s_add_u32 s3, s90, 4
    s_and_b32 s3, s3, 7
    s_mul_i32 s3, s3, 229376
    s_waitcnt lgkmcnt(7)
    v_mfma_f32_32x32x16_bf16 v[128:143], v[32:35], v[48:51], v[128:143]
    ds_read_b128 v[72:75], v15 offset:32768
    ds_read_b64_tr_b16 v[56:57], v10 offset:8192
    s_add_u32 s3, s3, s92
    s_add_u32 m0, s16, 65536
    s_nop 0
    buffer_load_dwordx4 v6, s[48:51], s3 offen  lds
    s_waitcnt lgkmcnt(8)
    v_mfma_f32_32x32x16_bf16 v[144:159], v[32:35], v[52:55], v[144:159]
    ds_read_b64_tr_b16 v[58:59], v10 offset:10240
    ds_read_b128 v[76:79], v15 offset:36864
    s_add_u32 s4, s90, 4
    s_and_b32 s4, s4, 7
    s_lshl_b32 s4, s4, 7
    s_waitcnt lgkmcnt(8)
    v_mfma_f32_32x32x16_bf16 v[160:175], v[36:39], v[48:51], v[160:175]
    ds_read_b64_tr_b16 v[60:61], v11 offset:8192
    ds_read_b64_tr_b16 v[62:63], v11 offset:10240
    s_add_u32 s4, s4, s91
    s_add_u32 m0, s20, 98304
    s_nop 0
    buffer_load_dwordx4 v2, s[44:47], s4 offen  lds
    s_add_u32 s96, s96, 9216
    s_add_u32 m0, s29, 34816
    s_nop 0
    buffer_load_dwordx4 v22, s[68:71], s96 offen offset:0  lds
    s_add_u32 s96, s96, 7168
    buffer_load_dwordx4 v22, s[68:71], s96 offen offset:1024  lds
    v_mfma_f32_32x32x16_bf16 v[176:191], v[36:39], v[52:55], v[176:191]
    ds_read_b64_tr_b16 v[64:65], v12 offset:8192
    ds_read_b64_tr_b16 v[66:67], v12 offset:10240
    s_waitcnt lgkmcnt(10)
    v_mfma_f32_32x32x16_bf16 v[192:207], v[40:43], v[48:51], v[192:207]
    ds_read_b64_tr_b16 v[68:69], v13 offset:8192
    ds_read_b64_tr_b16 v[70:71], v13 offset:10240
    v_mfma_f32_32x32x16_bf16 v[208:223], v[40:43], v[52:55], v[208:223]
    s_waitcnt lgkmcnt(10)
    v_mfma_f32_32x32x16_bf16 v[224:239], v[44:47], v[48:51], v[224:239]
    v_mfma_f32_32x32x16_bf16 v[240:255], v[44:47], v[52:55], v[240:255]
    s_waitcnt lgkmcnt(0)
    s_waitcnt vmcnt(18)
    s_barrier
    v_mfma_f32_32x32x16_bf16 v[128:143], v[56:59], v[72:75], v[128:143]
    ds_read_b128 v[48:51], v16 offset:32768
    ds_read_b64_tr_b16 v[32:33], v10 offset:16384
    s_add_u32 s93, s90, 3
    s_and_b32 s93, s93, 7
    s_mul_i32 s93, s93, 229376
    v_mfma_f32_32x32x16_bf16 v[144:159], v[56:59], v[76:79], v[144:159]
    ds_read_b64_tr_b16 v[34:35], v10 offset:18432
    ds_read_b128 v[52:55], v16 offset:36864
    s_add_u32 s93, s93, s92
    s_add_u32 s93, s93, 114688
    v_mfma_f32_32x32x16_bf16 v[160:175], v[60:63], v[72:75], v[160:175]
    ds_read_b64_tr_b16 v[36:37], v11 offset:16384
    ds_read_b64_tr_b16 v[38:39], v11 offset:18432
    s_add_u32 m0, s17, 49152
    s_nop 0
    buffer_load_dwordx4 v7, s[52:55], s93 offen  lds
    v_mfma_f32_32x32x16_bf16 v[176:191], v[60:63], v[76:79], v[176:191]
    ds_read_b64_tr_b16 v[40:41], v12 offset:16384
    ds_read_b64_tr_b16 v[42:43], v12 offset:18432
    s_add_u32 m0, s18, 49152
    s_nop 0
    buffer_load_dwordx4 v8, s[48:51], s93 offen  lds
    v_mfma_f32_32x32x16_bf16 v[192:207], v[64:67], v[72:75], v[192:207]
    ds_read_b64_tr_b16 v[44:45], v13 offset:16384
    ds_read_b64_tr_b16 v[46:47], v13 offset:18432
    s_add_u32 m0, s19, 49152
    s_nop 0
    buffer_load_dwordx4 v9, s[52:55], s93 offen  lds
    s_add_u32 s3, s90, 4
    v_mfma_f32_32x32x16_bf16 v[208:223], v[64:67], v[76:79], v[208:223]
    s_and_b32 s3, s3, 7
    s_mul_i32 s3, s3, 229376
    s_add_u32 s3, s3, s92
    s_add_u32 s3, s3, 114688
    v_mfma_f32_32x32x16_bf16 v[224:239], v[68:71], v[72:75], v[224:239]
    s_add_u32 m0, s16, 0
    s_nop 0
    buffer_load_dwordx4 v6, s[48:51], s3 offen  lds
    v_mfma_f32_32x32x16_bf16 v[240:255], v[68:71], v[76:79], v[240:255]
    s_waitcnt lgkmcnt(7)
    v_mfma_f32_32x32x16_bf16 v[128:143], v[32:35], v[48:51], v[128:143]
    ds_read_b128 v[72:75], v17 offset:32768
    ds_read_b64_tr_b16 v[56:57], v10 offset:24576
    s_waitcnt lgkmcnt(8)
    v_mfma_f32_32x32x16_bf16 v[144:159], v[32:35], v[52:55], v[144:159]
    ds_read_b64_tr_b16 v[58:59], v10 offset:26624
    ds_read_b128 v[76:79], v17 offset:36864
    s_waitcnt lgkmcnt(8)
    v_mfma_f32_32x32x16_bf16 v[160:175], v[36:39], v[48:51], v[160:175]
    ds_read_b64_tr_b16 v[60:61], v11 offset:24576
    ds_read_b64_tr_b16 v[62:63], v11 offset:26624
    s_lshl_b32 s96, s75, 3
    s_add_u32 m0, s29, 36864
    s_nop 0
    buffer_load_dwordx4 v22, s[68:71], s96 offen offset:0  lds
    s_add_u32 s96, s96, 7168
    buffer_load_dwordx4 v22, s[68:71], s96 offen offset:1024  lds
    v_mfma_f32_32x32x16_bf16 v[176:191], v[36:39], v[52:55], v[176:191]
    ds_read_b64_tr_b16 v[64:65], v12 offset:24576
    ds_read_b64_tr_b16 v[66:67], v12 offset:26624
    s_waitcnt lgkmcnt(10)
    v_mfma_f32_32x32x16_bf16 v[192:207], v[40:43], v[48:51], v[192:207]
    ds_read_b64_tr_b16 v[68:69], v13 offset:24576
    ds_read_b64_tr_b16 v[70:71], v13 offset:26624
    v_readfirstlane_b32 s101, v19
    s_lshr_b32 s7, s88, 1
    s_lshl_b32 s7, s7, 4
    v_mfma_f32_32x32x16_bf16 v[208:223], v[40:43], v[52:55], v[208:223]
    s_lshr_b32 s101, s101, s7
    s_lshl_b32 s101, s101, 16
    s_waitcnt lgkmcnt(10)
    v_mfma_f32_32x32x16_bf16 v[224:239], v[44:47], v[48:51], v[224:239]
    v_mfma_f32_32x32x16_bf16 v[240:255], v[44:47], v[52:55], v[240:255]
    s_waitcnt lgkmcnt(0)
    s_waitcnt vmcnt(10)
    s_barrier
    v_mfma_f32_32x32x16_bf16 v[128:143], v[56:59], v[72:75], v[128:143]
    ds_read_b128 v[48:51], v14 offset:0
    ds_read_b64_tr_b16 v[32:33], v10 offset:32768
    s_add_u32 s94, s90, 4
    s_and_b32 s94, s94, 7
    s_lshl_b32 s94, s94, 7
    v_mfma_f32_32x32x16_bf16 v[144:159], v[56:59], v[76:79], v[144:159]
    ds_read_b64_tr_b16 v[34:35], v10 offset:34816
    ds_read_b128 v[52:55], v14 offset:4096
    s_add_u32 s94, s94, s91
    s_add_u32 m0, s21, 98304
    s_nop 0
    buffer_load_dwordx4 v3, s[44:47], s94 offen  lds
    v_mfma_f32_32x32x16_bf16 v[160:175], v[60:63], v[72:75], v[160:175]
    ds_read_b64_tr_b16 v[36:37], v11 offset:32768
    ds_read_b64_tr_b16 v[38:39], v11 offset:34816
    s_add_u32 m0, s22, 98304
    s_nop 0
    buffer_load_dwordx4 v4, s[44:47], s94 offen  lds
    v_mfma_f32_32x32x16_bf16 v[176:191], v[60:63], v[76:79], v[176:191]
    ds_read_b64_tr_b16 v[40:41], v12 offset:32768
    ds_read_b64_tr_b16 v[42:43], v12 offset:34816
    s_add_u32 m0, s23, 98304
    s_nop 0
    buffer_load_dwordx4 v5, s[44:47], s94 offen  lds
    s_add_u32 s93, s90, 4
    v_mfma_f32_32x32x16_bf16 v[192:207], v[64:67], v[72:75], v[192:207]
    ds_read_b64_tr_b16 v[44:45], v13 offset:32768
    ds_read_b64_tr_b16 v[46:47], v13 offset:34816
    s_and_b32 s93, s93, 7
    s_mul_i32 s93, s93, 229376
    s_add_u32 s93, s93, s92
    v_mfma_f32_32x32x16_bf16 v[208:223], v[64:67], v[76:79], v[208:223]
    s_add_u32 m0, s17, 65536
    s_nop 0
    buffer_load_dwordx4 v7, s[52:55], s93 offen  lds
    s_add_u32 m0, s18, 65536
    s_nop 0
    buffer_load_dwordx4 v8, s[48:51], s93 offen  lds
    ds_read_b64_tr_b16 a[0:1], v20 offset:32768
    ds_read_b64_tr_b16 a[2:3], v20 offset:33792
    v_mfma_f32_32x32x16_bf16 v[224:239], v[68:71], v[72:75], v[224:239]
    s_add_u32 m0, s19, 65536
    s_nop 0
    buffer_load_dwordx4 v9, s[52:55], s93 offen  lds
    s_add_u32 s3, s90, 5
    s_and_b32 s3, s3, 7
    s_mul_i32 s3, s3, 229376
    ds_read_b64_tr_b16 a[4:5], v21 offset:32768
    ds_read_b64_tr_b16 a[6:7], v21 offset:33792
    v_mfma_f32_32x32x16_bf16 v[240:255], v[68:71], v[76:79], v[240:255]
    s_add_u32 s3, s3, s92
    s_add_u32 m0, s16, 16384
    s_nop 0
    buffer_load_dwordx4 v6, s[48:51], s3 offen  lds
    s_add_u32 s4, s90, 5
    s_and_b32 s4, s4, 7
    s_waitcnt lgkmcnt(11)
    v_mfma_f32_32x32x16_bf16 v[128:143], v[32:35], v[48:51], v[128:143]
    ds_read_b128 v[72:75], v15 offset:0
    ds_read_b64_tr_b16 v[56:57], v10 offset:40960
    s_lshl_b32 s4, s4, 7
    s_add_u32 s4, s4, s91
    s_waitcnt lgkmcnt(12)
    v_mfma_f32_32x32x16_bf16 v[144:159], v[32:35], v[52:55], v[144:159]
    ds_read_b64_tr_b16 v[58:59], v10 offset:43008
    ds_read_b128 v[76:79], v15 offset:4096
    s_add_u32 m0, s20, 114688
    s_nop 0
    buffer_load_dwordx4 v2, s[44:47], s4 offen  lds
    s_waitcnt lgkmcnt(12)
    v_mfma_f32_32x32x16_bf16 v[160:175], v[36:39], v[48:51], v[160:175]
    ds_read_b64_tr_b16 v[60:61], v11 offset:40960
    ds_read_b64_tr_b16 v[62:63], v11 offset:43008
    s_add_u32 s96, s96, 9216
    s_add_u32 m0, s29, 38912
    s_nop 0
    buffer_load_dwordx4 v22, s[68:71], s96 offen offset:0  lds
    s_add_u32 s96, s96, 7168
    buffer_load_dwordx4 v22, s[68:71], s96 offen offset:1024  lds
    v_mfma_f32_32x32x16_bf16 v[176:191], v[36:39], v[52:55], v[176:191]
    ds_read_b64_tr_b16 v[64:65], v12 offset:40960
    s_waitcnt lgkmcnt(14)
    ds_read_b64_tr_b16 v[66:67], v12 offset:43008
    s_waitcnt lgkmcnt(14)
    v_mfma_f32_32x32x16_bf16 v[192:207], v[40:43], v[48:51], v[192:207]
    ds_read_b64_tr_b16 v[68:69], v13 offset:40960
    s_waitcnt lgkmcnt(14)
    ds_read_b64_tr_b16 v[70:71], v13 offset:43008
    v_mfma_f32_32x32x16_bf16 v[208:223], v[40:43], v[52:55], v[208:223]
    v_mov_b32 v28, 0
    global_load_dwordx2 v[26:27], v28, s[40:41] sc1
    s_waitcnt lgkmcnt(14)
    v_mfma_f32_32x32x16_bf16 v[224:239], v[44:47], v[48:51], v[224:239]
    v_mfma_f32_32x32x16_bf16 v[240:255], v[44:47], v[52:55], v[240:255]
    s_waitcnt lgkmcnt(0)
    s_waitcnt vmcnt(14)
    s_barrier
    v_mfma_f32_32x32x16_bf16 v[128:143], v[56:59], v[72:75], v[128:143]
    ds_read_b128 v[48:51], v16 offset:0
    ds_read_b64_tr_b16 v[32:33], v10 offset:49152
    s_add_u32 s93, s90, 4
    s_and_b32 s93, s93, 7
    s_mul_i32 s93, s93, 229376
    v_mfma_f32_32x32x16_bf16 v[144:159], v[56:59], v[76:79], v[144:159]
    ds_read_b64_tr_b16 v[34:35], v10 offset:51200
    ds_read_b128 v[52:55], v16 offset:4096
    s_add_u32 s93, s93, s92
    s_add_u32 s93, s93, 114688
    v_mfma_f32_32x32x16_bf16 v[160:175], v[60:63], v[72:75], v[160:175]
    ds_read_b64_tr_b16 v[36:37], v11 offset:49152
    ds_read_b64_tr_b16 v[38:39], v11 offset:51200
    s_add_u32 m0, s17, 0
    s_nop 0
    buffer_load_dwordx4 v7, s[52:55], s93 offen  lds
    v_mfma_f32_32x32x16_bf16 v[176:191], v[60:63], v[76:79], v[176:191]
    ds_read_b64_tr_b16 v[40:41], v12 offset:49152
    ds_read_b64_tr_b16 v[42:43], v12 offset:51200
    s_add_u32 m0, s18, 0
    s_nop 0
    buffer_load_dwordx4 v8, s[48:51], s93 offen  lds
    v_mfma_f32_32x32x16_bf16 v[192:207], v[64:67], v[72:75], v[192:207]
    ds_read_b64_tr_b16 v[44:45], v13 offset:49152
    ds_read_b64_tr_b16 v[46:47], v13 offset:51200
    s_add_u32 m0, s19, 0
    s_nop 0
    buffer_load_dwordx4 v9, s[52:55], s93 offen  lds
    s_add_u32 s3, s90, 5
    v_mfma_f32_32x32x16_bf16 v[208:223], v[64:67], v[76:79], v[208:223]
    s_and_b32 s3, s3, 7
    s_mul_i32 s3, s3, 229376
    s_add_u32 s3, s3, s92
    s_add_u32 s3, s3, 114688
    ds_read_b64_tr_b16 a[8:9], v20 offset:34816
    ds_read_b64_tr_b16 a[10:11], v20 offset:35840
    ds_read_b64_tr_b16 a[12:13], v21 offset:34816
    v_mfma_f32_32x32x16_bf16 v[224:239], v[68:71], v[72:75], v[224:239]
    s_add_u32 m0, s16, 32768
    s_nop 0
    buffer_load_dwordx4 v6, s[48:51], s3 offen  lds
    ds_read_b64_tr_b16 a[14:15], v21 offset:35840
    v_mfma_f32_32x32x16_bf16 v[240:255], v[68:71], v[76:79], v[240:255]
    s_waitcnt lgkmcnt(11)
    v_mfma_f32_32x32x16_bf16 v[128:143], v[32:35], v[48:51], v[128:143]
    ds_read_b128 v[72:75], v17 offset:0
    ds_read_b64_tr_b16 v[56:57], v10 offset:57344
    s_waitcnt lgkmcnt(12)
    v_mfma_f32_32x32x16_bf16 v[144:159], v[32:35], v[52:55], v[144:159]
    ds_read_b64_tr_b16 v[58:59], v10 offset:59392
    ds_read_b128 v[76:79], v17 offset:4096
    s_waitcnt lgkmcnt(12)
    v_mfma_f32_32x32x16_bf16 v[160:175], v[36:39], v[48:51], v[160:175]
    ds_read_b64_tr_b16 v[60:61], v11 offset:57344
    ds_read_b64_tr_b16 v[62:63], v11 offset:59392
    s_lshl_b32 s96, s76, 3
    s_add_u32 m0, s29, 32768
    s_nop 0
    buffer_load_dwordx4 v22, s[68:71], s96 offen offset:0  lds
    s_add_u32 s96, s96, 7168
    buffer_load_dwordx4 v22, s[68:71], s96 offen offset:1024  lds
    v_mfma_f32_32x32x16_bf16 v[176:191], v[36:39], v[52:55], v[176:191]
    ds_read_b64_tr_b16 v[64:65], v12 offset:57344
    s_waitcnt lgkmcnt(14)
    ds_read_b64_tr_b16 v[66:67], v12 offset:59392
    s_waitcnt lgkmcnt(14)
    v_mfma_f32_32x32x16_bf16 v[192:207], v[40:43], v[48:51], v[192:207]
    ds_read_b64_tr_b16 v[68:69], v13 offset:57344
    s_waitcnt lgkmcnt(14)
    ds_read_b64_tr_b16 v[70:71], v13 offset:59392
    v_mfma_f32_32x32x16_bf16 v[208:223], v[40:43], v[52:55], v[208:223]
    s_waitcnt lgkmcnt(14)
    v_mfma_f32_32x32x16_bf16 v[224:239], v[44:47], v[48:51], v[224:239]
    v_mfma_f32_32x32x16_bf16 v[240:255], v[44:47], v[52:55], v[240:255]
    s_waitcnt lgkmcnt(0)
    s_waitcnt vmcnt(11)
    s_barrier
    v_mfma_f32_32x32x16_bf16 v[128:143], v[56:59], v[72:75], v[128:143]
    ds_read_b128 v[48:51], v14 offset:16384
    v_add_u32 v10, 0x10000, v10
    s_add_u32 s94, s90, 5
    s_and_b32 s94, s94, 7
    s_lshl_b32 s94, s94, 7
    v_mfma_f32_32x32x16_bf16 v[144:159], v[56:59], v[76:79], v[144:159]
    v_add_u32 v11, 0x10000, v11
    v_add_u32 v12, 0x10000, v12
    s_add_u32 s94, s94, s91
    s_add_u32 m0, s21, 114688
    s_nop 0
    buffer_load_dwordx4 v3, s[44:47], s94 offen  lds
    v_mfma_f32_32x32x16_bf16 v[160:175], v[60:63], v[72:75], v[160:175]
    v_add_u32 v13, 0x10000, v13
    ds_read_b64_tr_b16 v[32:33], v10 offset:0
    s_add_u32 m0, s22, 114688
    s_nop 0
    buffer_load_dwordx4 v4, s[44:47], s94 offen  lds
    v_mfma_f32_32x32x16_bf16 v[176:191], v[60:63], v[76:79], v[176:191]
    ds_read_b64_tr_b16 v[34:35], v10 offset:2048
    ds_read_b128 v[52:55], v14 offset:20480
    s_add_u32 m0, s23, 114688
    s_nop 0
    buffer_load_dwordx4 v5, s[44:47], s94 offen  lds
    s_add_u32 s93, s90, 5
    v_mfma_f32_32x32x16_bf16 v[192:207], v[64:67], v[72:75], v[192:207]
    ds_read_b64_tr_b16 v[36:37], v11 offset:0
    ds_read_b64_tr_b16 v[38:39], v11 offset:2048
    s_and_b32 s93, s93, 7
    s_mul_i32 s93, s93, 229376
    s_add_u32 s93, s93, s92
    v_mfma_f32_32x32x16_bf16 v[208:223], v[64:67], v[76:79], v[208:223]
    ds_read_b64_tr_b16 v[40:41], v12 offset:0
    ds_read_b64_tr_b16 v[42:43], v12 offset:2048
    s_add_u32 m0, s17, 16384
    s_nop 0
    buffer_load_dwordx4 v7, s[52:55], s93 offen  lds
    ds_read_b64_tr_b16 a[16:17], v20 offset:36864
    ds_read_b64_tr_b16 a[18:19], v20 offset:37888
    v_mfma_f32_32x32x16_bf16 v[224:239], v[68:71], v[72:75], v[224:239]
    ds_read_b64_tr_b16 v[44:45], v13 offset:0
    ds_read_b64_tr_b16 v[46:47], v13 offset:2048
    s_add_u32 m0, s18, 16384
    s_nop 0
    buffer_load_dwordx4 v8, s[48:51], s93 offen  lds
    ds_read_b64_tr_b16 a[20:21], v21 offset:36864
    ds_read_b64_tr_b16 a[22:23], v21 offset:37888
    v_mfma_f32_32x32x16_bf16 v[240:255], v[68:71], v[76:79], v[240:255]
    s_add_u32 m0, s19, 16384
    s_nop 0
    buffer_load_dwordx4 v9, s[52:55], s93 offen  lds
    s_add_u32 s3, s90, 6
    s_and_b32 s3, s3, 7
    s_mul_i32 s3, s3, 229376
    s_waitcnt lgkmcnt(11)
    v_mfma_f32_32x32x16_bf16 v[128:143], v[32:35], v[48:51], v[128:143]
    ds_read_b128 v[72:75], v15 offset:16384
    ds_read_b64_tr_b16 v[56:57], v10 offset:8192
    s_add_u32 s3, s3, s92
    s_add_u32 m0, s16, 49152
    s_nop 0
    buffer_load_dwordx4 v6, s[48:51], s3 offen  lds
    s_waitcnt lgkmcnt(12)
    v_mfma_f32_32x32x16_bf16 v[144:159], v[32:35], v[52:55], v[144:159]
    ds_read_b64_tr_b16 v[58:59], v10 offset:10240
    ds_read_b128 v[76:79], v15 offset:20480
    s_add_u32 s4, s90, 6
    s_and_b32 s4, s4, 7
    s_lshl_b32 s4, s4, 7
    s_waitcnt lgkmcnt(12)
    v_mfma_f32_32x32x16_bf16 v[160:175], v[36:39], v[48:51], v[160:175]
    ds_read_b64_tr_b16 v[60:61], v11 offset:8192
    ds_read_b64_tr_b16 v[62:63], v11 offset:10240
    s_add_u32 s4, s4, s91
    s_add_u32 m0, s20, 81920
    s_nop 0
    buffer_load_dwordx4 v2, s[44:47], s4 offen  lds
    s_add_u32 s96, s96, 9216
    s_add_u32 m0, s29, 34816
    s_nop 0
    buffer_load_dwordx4 v22, s[68:71], s96 offen offset:0  lds
    s_add_u32 s96, s96, 7168
    buffer_load_dwordx4 v22, s[68:71], s96 offen offset:1024  lds
    v_mfma_f32_32x32x16_bf16 v[176:191], v[36:39], v[52:55], v[176:191]
    ds_read_b64_tr_b16 v[64:65], v12 offset:8192
    s_waitcnt lgkmcnt(14)
    ds_read_b64_tr_b16 v[66:67], v12 offset:10240
    s_waitcnt vmcnt(16)
    v_cmp_ne_u32 vcc, 0, v26
    s_nop 0
    s_cmp_eq_u64 vcc, exec
    s_cbranch_scc1 L_nok_3
    s_mov_b32 s100, 0
    v_mov_b32 v28, 0
    L_nlp_4:
    global_load_dwordx2 v[26:27], v28, s[40:41] sc1
    s_waitcnt vmcnt(0)
    v_cmp_ne_u32 vcc, 0, v26
    s_add_u32 s100, s100, 1
    s_nop 1
    s_cmp_eq_u64 vcc, exec
    s_cbranch_scc1 L_nok_3
    s_sleep 4
    s_cmp_lt_u32 s100, 200000
    s_cbranch_scc1 L_nlp_4
L_nok_3:
    v_readfirstlane_b32 s72, v26
    v_readfirstlane_b32 s73, v27
    s_waitcnt lgkmcnt(14)
    v_mfma_f32_32x32x16_bf16 v[192:207], v[40:43], v[48:51], v[192:207]
    ds_read_b64_tr_b16 v[68:69], v13 offset:8192
    s_waitcnt lgkmcnt(14)
    ds_read_b64_tr_b16 v[70:71], v13 offset:10240
    v_mfma_f32_32x32x16_bf16 v[208:223], v[40:43], v[52:55], v[208:223]
    s_waitcnt lgkmcnt(12)
    v_mfma_f32_32x32x16_bf16 v[224:239], v[44:47], v[48:51], v[224:239]
    v_mfma_f32_32x32x16_bf16 v[240:255], v[44:47], v[52:55], v[240:255]
    s_waitcnt lgkmcnt(0)
    s_waitcnt vmcnt(13)
    s_barrier
    v_mfma_f32_32x32x16_bf16 v[128:143], v[56:59], v[72:75], v[128:143]
    ds_read_b128 v[48:51], v16 offset:16384
    v_subrev_u32 v10, 0x10000, v10
    s_add_u32 s93, s90, 5
    s_and_b32 s93, s93, 7
    s_mul_i32 s93, s93, 229376
    v_mfma_f32_32x32x16_bf16 v[144:159], v[56:59], v[76:79], v[144:159]
    v_subrev_u32 v11, 0x10000, v11
    v_subrev_u32 v12, 0x10000, v12
    s_add_u32 s93, s93, s92
    s_add_u32 s93, s93, 114688
    v_mfma_f32_32x32x16_bf16 v[160:175], v[60:63], v[72:75], v[160:175]
    v_subrev_u32 v13, 0x10000, v13
    ds_read_b64_tr_b16 v[32:33], v10 offset:0
    s_add_u32 m0, s17, 32768
    s_nop 0
    buffer_load_dwordx4 v7, s[52:55], s93 offen  lds
    v_mfma_f32_32x32x16_bf16 v[176:191], v[60:63], v[76:79], v[176:191]
    ds_read_b64_tr_b16 v[34:35], v10 offset:2048
    ds_read_b128 v[52:55], v16 offset:20480
    s_add_u32 m0, s18, 32768
    s_nop 0
    buffer_load_dwordx4 v8, s[48:51], s93 offen  lds
    v_mfma_f32_32x32x16_bf16 v[192:207], v[64:67], v[72:75], v[192:207]
    ds_read_b64_tr_b16 v[36:37], v11 offset:0
    ds_read_b64_tr_b16 v[38:39], v11 offset:2048
    s_add_u32 m0, s19, 32768
    s_nop 0
    buffer_load_dwordx4 v9, s[52:55], s93 offen  lds
    s_add_u32 s3, s90, 6
    v_mfma_f32_32x32x16_bf16 v[208:223], v[64:67], v[76:79], v[208:223]
    ds_read_b64_tr_b16 v[40:41], v12 offset:0
    ds_read_b64_tr_b16 v[42:43], v12 offset:2048
    s_and_b32 s3, s3, 7
    s_mul_i32 s3, s3, 229376
    s_add_u32 s3, s3, s92
    ds_read_b64_tr_b16 a[24:25], v20 offset:38912
    v_mfma_f32_32x32x16_bf16 v[224:239], v[68:71], v[72:75], v[224:239]
    ds_read_b64_tr_b16 v[44:45], v13 offset:0
    ds_read_b64_tr_b16 v[46:47], v13 offset:2048
    s_add_u32 s3, s3, 114688
    s_add_u32 m0, s16, 65536
    s_nop 0
    buffer_load_dwordx4 v6, s[48:51], s3 offen  lds
    ds_read_b64_tr_b16 a[26:27], v20 offset:39936
    v_mfma_f32_32x32x16_bf16 v[240:255], v[68:71], v[76:79], v[240:255]
    ds_read_b64_tr_b16 a[28:29], v21 offset:38912
    ds_read_b64_tr_b16 a[30:31], v21 offset:39936
    s_waitcnt lgkmcnt(11)
    v_mfma_f32_32x32x16_bf16 v[128:143], v[32:35], v[48:51], v[128:143]
    ds_read_b128 v[72:75], v17 offset:16384
    ds_read_b64_tr_b16 v[56:57], v10 offset:8192
    s_waitcnt lgkmcnt(12)
    v_mfma_f32_32x32x16_bf16 v[144:159], v[32:35], v[52:55], v[144:159]
    ds_read_b64_tr_b16 v[58:59], v10 offset:10240
    ds_read_b128 v[76:79], v17 offset:20480
    s_waitcnt lgkmcnt(12)
    v_mfma_f32_32x32x16_bf16 v[160:175], v[36:39], v[48:51], v[160:175]
    ds_read_b64_tr_b16 v[60:61], v11 offset:8192
    ds_read_b64_tr_b16 v[62:63], v11 offset:10240
    s_lshl_b32 s96, s77, 3
    s_add_u32 m0, s29, 36864
    s_nop 0
    buffer_load_dwordx4 v22, s[68:71], s96 offen offset:0  lds
    s_add_u32 s96, s96, 7168
    buffer_load_dwordx4 v22, s[68:71], s96 offen offset:1024  lds
    v_mfma_f32_32x32x16_bf16 v[176:191], v[36:39], v[52:55], v[176:191]
    ds_read_b64_tr_b16 v[64:65], v12 offset:8192
    s_waitcnt lgkmcnt(14)
    ds_read_b64_tr_b16 v[66:67], v12 offset:10240
    s_waitcnt lgkmcnt(14)
    v_mfma_f32_32x32x16_bf16 v[192:207], v[40:43], v[48:51], v[192:207]
    ds_read_b64_tr_b16 v[68:69], v13 offset:8192
    s_waitcnt lgkmcnt(14)
    ds_read_b64_tr_b16 v[70:71], v13 offset:10240
    v_mfma_f32_32x32x16_bf16 v[208:223], v[40:43], v[52:55], v[208:223]
    s_waitcnt lgkmcnt(13)
    v_mfma_f32_32x32x16_bf16 v[224:239], v[44:47], v[48:51], v[224:239]
    v_mfma_f32_32x32x16_bf16 v[240:255], v[44:47], v[52:55], v[240:255]
    s_waitcnt lgkmcnt(0)
    s_waitcnt vmcnt(10)
    s_barrier
    v_mfma_f32_32x32x16_bf16 v[128:143], v[56:59], v[72:75], v[128:143]
    ds_read_b128 v[48:51], v14 offset:32768
    ds_read_b64_tr_b16 v[32:33], v10 offset:16384
    s_add_u32 s94, s90, 6
    s_and_b32 s94, s94, 7
    s_lshl_b32 s94, s94, 7
    v_mfma_f32_32x32x16_bf16 v[144:159], v[56:59], v[76:79], v[144:159]
    ds_read_b64_tr_b16 v[34:35], v10 offset:18432
    ds_read_b128 v[52:55], v14 offset:36864
    s_add_u32 s94, s94, s91
    s_add_u32 m0, s21, 81920
    s_nop 0
    buffer_load_dwordx4 v3, s[44:47], s94 offen  lds
    v_mfma_f32_32x32x16_bf16 v[160:175], v[60:63], v[72:75], v[160:175]
    ds_read_b64_tr_b16 v[36:37], v11 offset:16384
    ds_read_b64_tr_b16 v[38:39], v11 offset:18432
    s_add_u32 m0, s22, 81920
    s_nop 0
    buffer_load_dwordx4 v4, s[44:47], s94 offen  lds
    v_mfma_f32_32x32x16_bf16 v[176:191], v[60:63], v[76:79], v[176:191]
    ds_read_b64_tr_b16 v[40:41], v12 offset:16384
    ds_read_b64_tr_b16 v[42:43], v12 offset:18432
    s_add_u32 m0, s23, 81920
    s_nop 0
    buffer_load_dwordx4 v5, s[44:47], s94 offen  lds
    s_add_u32 s93, s90, 6
    v_mfma_f32_32x32x16_bf16 v[192:207], v[64:67], v[72:75], v[192:207]
    ds_read_b64_tr_b16 v[44:45], v13 offset:16384
    ds_read_b64_tr_b16 v[46:47], v13 offset:18432
    s_and_b32 s93, s93, 7
    s_mul_i32 s93, s93, 229376
    s_add_u32 s93, s93, s92
    v_mfma_f32_32x32x16_bf16 v[208:223], v[64:67], v[76:79], v[208:223]
    s_add_u32 m0, s17, 49152
    s_nop 0
    buffer_load_dwordx4 v7, s[52:55], s93 offen  lds
    s_add_u32 m0, s18, 49152
    s_nop 0
    buffer_load_dwordx4 v8, s[48:51], s93 offen  lds
    ds_read_b64_tr_b16 a[32:33], v20 offset:32768
    ds_read_b64_tr_b16 a[34:35], v20 offset:33792
    v_mfma_f32_32x32x16_bf16 v[224:239], v[68:71], v[72:75], v[224:239]
    s_add_u32 m0, s19, 49152
    s_nop 0
    buffer_load_dwordx4 v9, s[52:55], s93 offen  lds
    s_add_u32 s3, s90, 7
    s_and_b32 s3, s3, 7
    s_mul_i32 s3, s3, 229376
    ds_read_b64_tr_b16 a[36:37], v21 offset:32768
    ds_read_b64_tr_b16 a[38:39], v21 offset:33792
    v_mfma_f32_32x32x16_bf16 v[240:255], v[68:71], v[76:79], v[240:255]
    s_add_u32 s3, s3, s92
    s_add_u32 m0, s16, 0
    s_nop 0
    buffer_load_dwordx4 v6, s[48:51], s3 offen  lds
    s_add_u32 s4, s90, 7
    s_and_b32 s4, s4, 7
    s_waitcnt lgkmcnt(11)
    v_mfma_f32_32x32x16_bf16 v[128:143], v[32:35], v[48:51], v[128:143]
    ds_read_b128 v[72:75], v15 offset:32768
    ds_read_b64_tr_b16 v[56:57], v10 offset:24576
    s_lshl_b32 s4, s4, 7
    s_add_u32 s4, s4, s91
    s_waitcnt lgkmcnt(12)
    v_mfma_f32_32x32x16_bf16 v[144:159], v[32:35], v[52:55], v[144:159]
    ds_read_b64_tr_b16 v[58:59], v10 offset:26624
    ds_read_b128 v[76:79], v15 offset:36864
    s_add_u32 m0, s20, 98304
    s_nop 0
    buffer_load_dwordx4 v2, s[44:47], s4 offen  lds
    s_waitcnt lgkmcnt(12)
    v_mfma_f32_32x32x16_bf16 v[160:175], v[36:39], v[48:51], v[160:175]
    ds_read_b64_tr_b16 v[60:61], v11 offset:24576
    ds_read_b64_tr_b16 v[62:63], v11 offset:26624
    s_add_u32 s96, s96, 9216
    s_add_u32 m0, s29, 38912
    s_nop 0
    buffer_load_dwordx4 v22, s[68:71], s96 offen offset:0  lds
    s_add_u32 s96, s96, 7168
    buffer_load_dwordx4 v22, s[68:71], s96 offen offset:1024  lds
    v_mfma_f32_32x32x16_bf16 v[176:191], v[36:39], v[52:55], v[176:191]
    ds_read_b64_tr_b16 v[64:65], v12 offset:24576
    s_waitcnt lgkmcnt(14)
    ds_read_b64_tr_b16 v[66:67], v12 offset:26624
    s_waitcnt lgkmcnt(14)
    v_mfma_f32_32x32x16_bf16 v[192:207], v[40:43], v[48:51], v[192:207]
    ds_read_b64_tr_b16 v[68:69], v13 offset:24576
    s_waitcnt lgkmcnt(14)
    ds_read_b64_tr_b16 v[70:71], v13 offset:26624
    v_mfma_f32_32x32x16_bf16 v[208:223], v[40:43], v[52:55], v[208:223]
    s_waitcnt lgkmcnt(14)
    v_mfma_f32_32x32x16_bf16 v[224:239], v[44:47], v[48:51], v[224:239]
    v_mfma_f32_32x32x16_bf16 v[240:255], v[44:47], v[52:55], v[240:255]
    s_waitcnt lgkmcnt(0)
    s_waitcnt vmcnt(13)
    s_barrier
    v_mfma_f32_32x32x16_bf16 v[128:143], v[56:59], v[72:75], v[128:143]
    ds_read_b128 v[48:51], v16 offset:32768
    ds_read_b64_tr_b16 v[32:33], v10 offset:32768
    s_add_u32 s93, s90, 6
    s_and_b32 s93, s93, 7
    s_mul_i32 s93, s93, 229376
    v_mfma_f32_32x32x16_bf16 v[144:159], v[56:59], v[76:79], v[144:159]
    ds_read_b64_tr_b16 v[34:35], v10 offset:34816
    ds_read_b128 v[52:55], v16 offset:36864
    s_add_u32 s93, s93, s92
    s_add_u32 s93, s93, 114688
    v_mfma_f32_32x32x16_bf16 v[160:175], v[60:63], v[72:75], v[160:175]
    ds_read_b64_tr_b16 v[36:37], v11 offset:32768
    ds_read_b64_tr_b16 v[38:39], v11 offset:34816
    s_add_u32 m0, s17, 65536
    s_nop 0
    buffer_load_dwordx4 v7, s[52:55], s93 offen  lds
    v_mfma_f32_32x32x16_bf16 v[176:191], v[60:63], v[76:79], v[176:191]
    ds_read_b64_tr_b16 v[40:41], v12 offset:32768
    ds_read_b64_tr_b16 v[42:43], v12 offset:34816
    s_add_u32 m0, s18, 65536
    s_nop 0
    buffer_load_dwordx4 v8, s[48:51], s93 offen  lds
    v_mfma_f32_32x32x16_bf16 v[192:207], v[64:67], v[72:75], v[192:207]
    ds_read_b64_tr_b16 v[44:45], v13 offset:32768
    ds_read_b64_tr_b16 v[46:47], v13 offset:34816
    s_add_u32 m0, s19, 65536
    s_nop 0
    buffer_load_dwordx4 v9, s[52:55], s93 offen  lds
    s_add_u32 s3, s90, 7
    v_mfma_f32_32x32x16_bf16 v[208:223], v[64:67], v[76:79], v[208:223]
    s_and_b32 s3, s3, 7
    s_mul_i32 s3, s3, 229376
    s_add_u32 s3, s3, s92
    s_add_u32 s3, s3, 114688
    ds_read_b64_tr_b16 a[40:41], v20 offset:34816
    ds_read_b64_tr_b16 a[42:43], v20 offset:35840
    ds_read_b64_tr_b16 a[44:45], v21 offset:34816
    v_mfma_f32_32x32x16_bf16 v[224:239], v[68:71], v[72:75], v[224:239]
    s_add_u32 m0, s16, 16384
    s_nop 0
    buffer_load_dwordx4 v6, s[48:51], s3 offen  lds
    ds_read_b64_tr_b16 a[46:47], v21 offset:35840
    v_mfma_f32_32x32x16_bf16 v[240:255], v[68:71], v[76:79], v[240:255]
    s_waitcnt lgkmcnt(11)
    v_mfma_f32_32x32x16_bf16 v[128:143], v[32:35], v[48:51], v[128:143]
    ds_read_b128 v[72:75], v17 offset:32768
    ds_read_b64_tr_b16 v[56:57], v10 offset:40960
    s_waitcnt lgkmcnt(12)
    v_mfma_f32_32x32x16_bf16 v[144:159], v[32:35], v[52:55], v[144:159]
    ds_read_b64_tr_b16 v[58:59], v10 offset:43008
    ds_read_b128 v[76:79], v17 offset:36864
    s_waitcnt lgkmcnt(12)
    v_mfma_f32_32x32x16_bf16 v[160:175], v[36:39], v[48:51], v[160:175]
    ds_read_b64_tr_b16 v[60:61], v11 offset:40960
    ds_read_b64_tr_b16 v[62:63], v11 offset:43008
    s_lshl_b32 s96, s78, 3
    s_add_u32 m0, s29, 32768
    s_nop 0
    buffer_load_dwordx4 v22, s[68:71], s96 offen offset:0  lds
    s_add_u32 s96, s96, 7168
    buffer_load_dwordx4 v22, s[68:71], s96 offen offset:1024  lds
    v_mfma_f32_32x32x16_bf16 v[176:191], v[36:39], v[52:55], v[176:191]
    ds_read_b64_tr_b16 v[64:65], v12 offset:40960
    s_waitcnt lgkmcnt(14)
    ds_read_b64_tr_b16 v[66:67], v12 offset:43008
    s_waitcnt lgkmcnt(14)
    v_mfma_f32_32x32x16_bf16 v[192:207], v[40:43], v[48:51], v[192:207]
    ds_read_b64_tr_b16 v[68:69], v13 offset:40960
    s_waitcnt lgkmcnt(14)
    ds_read_b64_tr_b16 v[70:71], v13 offset:43008
    v_mfma_f32_32x32x16_bf16 v[208:223], v[40:43], v[52:55], v[208:223]
    s_waitcnt lgkmcnt(14)
    v_mfma_f32_32x32x16_bf16 v[224:239], v[44:47], v[48:51], v[224:239]
    v_mfma_f32_32x32x16_bf16 v[240:255], v[44:47], v[52:55], v[240:255]
    s_waitcnt lgkmcnt(0)
    s_waitcnt vmcnt(10)
    s_barrier
    v_mfma_f32_32x32x16_bf16 v[128:143], v[56:59], v[72:75], v[128:143]
    ds_read_b128 v[48:51], v14 offset:0
    ds_read_b64_tr_b16 v[32:33], v10 offset:49152
    s_add_u32 s94, s90, 7
    s_and_b32 s94, s94, 7
    s_lshl_b32 s94, s94, 7
    v_mfma_f32_32x32x16_bf16 v[144:159], v[56:59], v[76:79], v[144:159]
    ds_read_b64_tr_b16 v[34:35], v10 offset:51200
    ds_read_b128 v[52:55], v14 offset:4096
    s_add_u32 s94, s94, s91
    s_add_u32 m0, s21, 98304
    s_nop 0
    buffer_load_dwordx4 v3, s[44:47], s94 offen  lds
    v_mfma_f32_32x32x16_bf16 v[160:175], v[60:63], v[72:75], v[160:175]
    ds_read_b64_tr_b16 v[36:37], v11 offset:49152
    ds_read_b64_tr_b16 v[38:39], v11 offset:51200
    s_add_u32 m0, s22, 98304
    s_nop 0
    buffer_load_dwordx4 v4, s[44:47], s94 offen  lds
    v_mfma_f32_32x32x16_bf16 v[176:191], v[60:63], v[76:79], v[176:191]
    ds_read_b64_tr_b16 v[40:41], v12 offset:49152
    ds_read_b64_tr_b16 v[42:43], v12 offset:51200
    s_add_u32 m0, s23, 98304
    s_nop 0
    buffer_load_dwordx4 v5, s[44:47], s94 offen  lds
    s_add_u32 s93, s90, 7
    v_mfma_f32_32x32x16_bf16 v[192:207], v[64:67], v[72:75], v[192:207]
    ds_read_b64_tr_b16 v[44:45], v13 offset:49152
    ds_read_b64_tr_b16 v[46:47], v13 offset:51200
    s_and_b32 s93, s93, 7
    s_mul_i32 s93, s93, 229376
    s_add_u32 s93, s93, s92
    v_mfma_f32_32x32x16_bf16 v[208:223], v[64:67], v[76:79], v[208:223]
    s_add_u32 m0, s17, 0
    s_nop 0
    buffer_load_dwordx4 v7, s[52:55], s93 offen  lds
    s_add_u32 m0, s18, 0
    s_nop 0
    buffer_load_dwordx4 v8, s[48:51], s93 offen  lds
    ds_read_b64_tr_b16 a[48:49], v20 offset:36864
    ds_read_b64_tr_b16 a[50:51], v20 offset:37888
    v_mfma_f32_32x32x16_bf16 v[224:239], v[68:71], v[72:75], v[224:239]
    s_add_u32 m0, s19, 0
    s_nop 0
    buffer_load_dwordx4 v9, s[52:55], s93 offen  lds
    ds_read_b64_tr_b16 a[52:53], v21 offset:36864
    ds_read_b64_tr_b16 a[54:55], v21 offset:37888
    v_mfma_f32_32x32x16_bf16 v[240:255], v[68:71], v[76:79], v[240:255]
    s_waitcnt lgkmcnt(11)
    v_mfma_f32_32x32x16_bf16 v[128:143], v[32:35], v[48:51], v[128:143]
    ds_read_b128 v[72:75], v15 offset:0
    ds_read_b64_tr_b16 v[56:57], v10 offset:57344
    s_waitcnt lgkmcnt(12)
    v_mfma_f32_32x32x16_bf16 v[144:159], v[32:35], v[52:55], v[144:159]
    ds_read_b64_tr_b16 v[58:59], v10 offset:59392
    ds_read_b128 v[76:79], v15 offset:4096
    s_waitcnt lgkmcnt(12)
    v_mfma_f32_32x32x16_bf16 v[160:175], v[36:39], v[48:51], v[160:175]
    ds_read_b64_tr_b16 v[60:61], v11 offset:57344
    ds_read_b64_tr_b16 v[62:63], v11 offset:59392
    s_add_u32 s96, s96, 9216
    s_add_u32 m0, s29, 34816
    s_nop 0
    buffer_load_dwordx4 v22, s[68:71], s96 offen offset:0  lds
    s_add_u32 s96, s96, 7168
    buffer_load_dwordx4 v22, s[68:71], s96 offen offset:1024  lds
    v_mfma_f32_32x32x16_bf16 v[176:191], v[36:39], v[52:55], v[176:191]
    ds_read_b64_tr_b16 v[64:65], v12 offset:57344
    s_waitcnt lgkmcnt(14)
    ds_read_b64_tr_b16 v[66:67], v12 offset:59392
    s_waitcnt lgkmcnt(14)
    v_mfma_f32_32x32x16_bf16 v[192:207], v[40:43], v[48:51], v[192:207]
    ds_read_b64_tr_b16 v[68:69], v13 offset:57344
    s_waitcnt lgkmcnt(14)
    ds_read_b64_tr_b16 v[70:71], v13 offset:59392
    v_mfma_f32_32x32x16_bf16 v[208:223], v[40:43], v[52:55], v[208:223]
    s_waitcnt lgkmcnt(14)
    v_mfma_f32_32x32x16_bf16 v[224:239], v[44:47], v[48:51], v[224:239]
    v_mfma_f32_32x32x16_bf16 v[240:255], v[44:47], v[52:55], v[240:255]
    s_waitcnt lgkmcnt(0)
    s_waitcnt vmcnt(11)
    s_barrier
    v_mfma_f32_32x32x16_bf16 v[128:143], v[56:59], v[72:75], v[128:143]
    ds_read_b128 v[48:51], v16 offset:0
    v_add_u32 v10, 0x10000, v10
    s_add_u32 s93, s90, 7
    s_and_b32 s93, s93, 7
    s_mul_i32 s93, s93, 229376
    v_mfma_f32_32x32x16_bf16 v[144:159], v[56:59], v[76:79], v[144:159]
    v_add_u32 v11, 0x10000, v11
    v_add_u32 v12, 0x10000, v12
    s_add_u32 s93, s93, s92
    s_add_u32 s93, s93, 114688
    v_mfma_f32_32x32x16_bf16 v[160:175], v[60:63], v[72:75], v[160:175]
    v_add_u32 v13, 0x10000, v13
    ds_read_b64_tr_b16 v[32:33], v10 offset:0
    s_add_u32 m0, s17, 16384
    s_nop 0
    buffer_load_dwordx4 v7, s[52:55], s93 offen  lds
    v_mfma_f32_32x32x16_bf16 v[176:191], v[60:63], v[76:79], v[176:191]
    ds_read_b64_tr_b16 v[34:35], v10 offset:2048
    ds_read_b128 v[52:55], v16 offset:4096
    s_add_u32 m0, s18, 16384
    s_nop 0
    buffer_load_dwordx4 v8, s[48:51], s93 offen  lds
    v_mfma_f32_32x32x16_bf16 v[192:207], v[64:67], v[72:75], v[192:207]
    ds_read_b64_tr_b16 v[36:37], v11 offset:0
    ds_read_b64_tr_b16 v[38:39], v11 offset:2048
    s_add_u32 m0, s19, 16384
    s_nop 0
    buffer_load_dwordx4 v9, s[52:55], s93 offen  lds
    s_lshl_b32 s6, s88, 14
    v_mfma_f32_32x32x16_bf16 v[208:223], v[64:67], v[76:79], v[208:223]
    ds_read_b64_tr_b16 v[40:41], v12 offset:0
    ds_read_b64_tr_b16 v[42:43], v12 offset:2048
    ds_read_b64_tr_b16 a[56:57], v20 offset:38912
    ds_read_b64_tr_b16 a[58:59], v20 offset:39936
    ds_read_b64_tr_b16 a[60:61], v21 offset:38912
    ds_read_b64_tr_b16 a[62:63], v21 offset:39936
    v_mfma_f32_32x32x16_bf16 v[224:239], v[68:71], v[72:75], v[224:239]
    ds_read_b64_tr_b16 v[44:45], v13 offset:0
    ds_read_b64_tr_b16 v[46:47], v13 offset:2048
    s_add_u32 s6, s6, 32768
    v_and_b32 v30, 3, v0
    v_mul_u32_u24 v30, 2368, v30
    v_mfma_f32_32x32x16_bf16 v[240:255], v[68:71], v[76:79], v[240:255]
    v_and_b32 v31, 28, v0
    v_lshl_add_u32 v30, v31, 1, v30
    v_lshrrev_b32 v31, 5, v0
    v_lshlrev_b32 v31, 4, v31
    v_sub_u32 v30, v30, v31
    s_waitcnt lgkmcnt(11)
    v_mfma_f32_32x32x16_bf16 v[128:143], v[32:35], v[48:51], v[128:143]
    ds_read_b128 v[72:75], v17 offset:0
    ds_read_b64_tr_b16 v[56:57], v10 offset:8192
    s_add_u32 s7, s6, 16
    v_add_u32 v18, s7, v30
    v_and_b32 v30, 31, v0
    s_waitcnt lgkmcnt(12)
    v_mfma_f32_32x32x16_bf16 v[144:159], v[32:35], v[52:55], v[144:159]
    ds_read_b64_tr_b16 v[58:59], v10 offset:10240
    ds_read_b128 v[76:79], v17 offset:4096
    v_mul_u32_u24 v30, 144, v30
    s_add_u32 s7, s6, 9280
    s_waitcnt lgkmcnt(12)
    v_mfma_f32_32x32x16_bf16 v[160:175], v[36:39], v[48:51], v[160:175]
    ds_read_b64_tr_b16 v[60:61], v11 offset:8192
    ds_read_b64_tr_b16 v[62:63], v11 offset:10240
    s_lshl_b32 s96, s79, 3
    s_add_u32 m0, s29, 36864
    s_nop 0
    buffer_load_dwordx4 v22, s[68:71], s96 offen offset:0  lds
    s_add_u32 s96, s96, 7168
    buffer_load_dwordx4 v22, s[68:71], s96 offen offset:1024  lds
    v_mfma_f32_32x32x16_bf16 v[176:191], v[36:39], v[52:55], v[176:191]
    ds_read_b64_tr_b16 v[64:65], v12 offset:8192
    s_waitcnt lgkmcnt(14)
    ds_read_b64_tr_b16 v[66:67], v12 offset:10240
    v_add3_u32 v19, v30, v31, s7
    s_waitcnt lgkmcnt(14)
    v_mfma_f32_32x32x16_bf16 v[192:207], v[40:43], v[48:51], v[192:207]
    ds_read_b64_tr_b16 v[68:69], v13 offset:8192
    s_waitcnt lgkmcnt(14)
    ds_read_b64_tr_b16 v[70:71], v13 offset:10240
    v_mfma_f32_32x32x16_bf16 v[208:223], v[40:43], v[52:55], v[208:223]
    s_waitcnt lgkmcnt(10)
    v_mfma_f32_32x32x16_bf16 v[224:239], v[44:47], v[48:51], v[224:239]
    v_mfma_f32_32x32x16_bf16 v[240:255], v[44:47], v[52:55], v[240:255]
    s_waitcnt lgkmcnt(0)
    s_waitcnt vmcnt(7)
    s_barrier
    v_mfma_f32_32x32x16_bf16 v[128:143], v[56:59], v[72:75], v[128:143]
    ds_read_b128 v[48:51], v14 offset:16384
    v_subrev_u32 v10, 0x10000, v10
    s_lshl_b32 s6, s88, 14
    s_add_u32 s6, s6, 42048
    v_add_u32 v110, s6, v1
    v_mfma_f32_32x32x16_bf16 v[144:159], v[56:59], v[76:79], v[144:159]
    v_subrev_u32 v11, 0x10000, v11
    v_subrev_u32 v12, 0x10000, v12
    v_mov_b32 v98, 0
    v_mov_b32 v99, 0
    v_mov_b32 v100, 0
    v_mfma_f32_32x32x16_bf16 v[160:175], v[60:63], v[72:75], v[160:175]
    v_subrev_u32 v13, 0x10000, v13
    ds_read_b64_tr_b16 v[32:33], v10 offset:0
    s_lshr_b32 s14, s89, 5
    v_and_b32 v23, 3, v0
    v_sub_u32 v23, s14, v23
    v_and_b32 v23, 7, v23
    v_lshlrev_b32 v23, 7, v23
    v_mfma_f32_32x32x16_bf16 v[176:191], v[60:63], v[76:79], v[176:191]
    ds_read_b64_tr_b16 v[34:35], v10 offset:2048
    ds_read_b128 v[52:55], v14 offset:20480
    s_lshl_b32 s14, s88, 10
    s_add_u32 s14, s14, 14024704
    buffer_load_dwordx2 v[24:25], v23, s[56:59], s14 offen sc1
    v_mfma_f32_32x32x16_bf16 v[192:207], v[64:67], v[72:75], v[192:207]
    ds_read_b64_tr_b16 v[36:37], v11 offset:0
    ds_read_b64_tr_b16 v[38:39], v11 offset:2048
    v_mov_b32 v101, 0
    ds_write_b128 v110, v[98:101] offset:0
    v_mfma_f32_32x32x16_bf16 v[208:223], v[64:67], v[76:79], v[208:223]
    ds_read_b64_tr_b16 v[40:41], v12 offset:0
    ds_read_b64_tr_b16 v[42:43], v12 offset:2048
    ds_read_b64_tr_b16 a[64:65], v20 offset:32768
    ds_read_b64_tr_b16 a[66:67], v20 offset:33792
    ds_read_b64_tr_b16 a[68:69], v21 offset:32768
    ds_read_b64_tr_b16 a[70:71], v21 offset:33792
    v_mfma_f32_32x32x16_bf16 v[224:239], v[68:71], v[72:75], v[224:239]
    ds_read_b64_tr_b16 v[44:45], v13 offset:0
    ds_read_b64_tr_b16 v[46:47], v13 offset:2048
    s_waitcnt lgkmcnt(14)
    ds_write_b128 v110, v[98:101] offset:1024
    s_waitcnt lgkmcnt(14)
    ds_write_b128 v110, v[98:101] offset:2048
    v_mfma_f32_32x32x16_bf16 v[240:255], v[68:71], v[76:79], v[240:255]
    s_waitcnt lgkmcnt(14)
    ds_write_b128 v110, v[98:101] offset:3072
    s_waitcnt lgkmcnt(14)
    ds_write_b128 v110, v[98:101] offset:4096
    s_lshl_b32 s6, s88, 14
    s_add_u32 s6, s6, 32768
    v_add_u32 v111, s6, v1
    v_alignbyte_b32 v98, v81, v80, 2
    v_mfma_f32_32x32x16_bf16 v[128:143], v[32:35], v[48:51], v[128:143]
    s_waitcnt lgkmcnt(14)
    ds_read_b128 v[72:75], v15 offset:16384
    s_waitcnt lgkmcnt(14)
    ds_read_b64_tr_b16 v[56:57], v10 offset:8192
    v_alignbyte_b32 v99, v82, v81, 2
    v_alignbyte_b32 v100, v83, v82, 2
    v_alignbyte_b32 v101, v84, v83, 2
    v_mfma_f32_32x32x16_bf16 v[144:159], v[32:35], v[52:55], v[144:159]
    s_waitcnt lgkmcnt(14)
    ds_read_b64_tr_b16 v[58:59], v10 offset:10240
    s_waitcnt lgkmcnt(14)
    ds_read_b128 v[76:79], v15 offset:20480
    v_mov_b32 v102, v81
    v_mov_b32 v103, v82
    v_mov_b32 v104, v83
    v_mov_b32 v105, v84
    v_mfma_f32_32x32x16_bf16 v[160:175], v[36:39], v[48:51], v[160:175]
    s_waitcnt lgkmcnt(14)
    ds_read_b64_tr_b16 v[60:61], v11 offset:8192
    s_waitcnt lgkmcnt(14)
    ds_read_b64_tr_b16 v[62:63], v11 offset:10240
    s_add_u32 s96, s96, 9216
    s_add_u32 m0, s29, 38912
    s_nop 0
    buffer_load_dwordx4 v22, s[68:71], s96 offen offset:0  lds
    s_add_u32 s96, s96, 7168
    buffer_load_dwordx4 v22, s[68:71], s96 offen offset:1024  lds
    v_mfma_f32_32x32x16_bf16 v[176:191], v[36:39], v[52:55], v[176:191]
    s_waitcnt lgkmcnt(14)
    ds_read_b64_tr_b16 v[64:65], v12 offset:8192
    s_waitcnt lgkmcnt(14)
    ds_read_b64_tr_b16 v[66:67], v12 offset:10240
    v_alignbyte_b32 v106, v82, v81, 2
    v_alignbyte_b32 v107, v83, v82, 2
    v_alignbyte_b32 v108, v84, v83, 2
    v_mfma_f32_32x32x16_bf16 v[192:207], v[40:43], v[48:51], v[192:207]
    s_waitcnt lgkmcnt(14)
    ds_read_b64_tr_b16 v[68:69], v13 offset:8192
    s_waitcnt lgkmcnt(14)
    ds_read_b64_tr_b16 v[70:71], v13 offset:10240
    v_alignbyte_b32 v109, v85, v84, 2
    s_waitcnt lgkmcnt(14)
    ds_write_b128 v111, v[98:101] offset:0
    s_waitcnt lgkmcnt(14)
    ds_write_b128 v111, v[102:105] offset:2368
    v_mfma_f32_32x32x16_bf16 v[208:223], v[40:43], v[52:55], v[208:223]
    s_waitcnt lgkmcnt(14)
    ds_write_b128 v111, v[106:109] offset:4736
    s_waitcnt lgkmcnt(14)
    ds_write_b128 v111, v[82:85] offset:7104
    v_alignbyte_b32 v98, v87, v86, 2
    v_alignbyte_b32 v99, v88, v87, 2
    v_alignbyte_b32 v100, v89, v88, 2
    v_mfma_f32_32x32x16_bf16 v[224:239], v[44:47], v[48:51], v[224:239]
    v_alignbyte_b32 v101, v90, v89, 2
    v_mov_b32 v102, v87
    v_mov_b32 v103, v88
    v_mov_b32 v104, v89
    v_mov_b32 v105, v90
    v_alignbyte_b32 v106, v88, v87, 2
    v_mfma_f32_32x32x16_bf16 v[240:255], v[44:47], v[52:55], v[240:255]
    s_waitcnt vmcnt(2)
    v_cmp_eq_u64 vcc, s[72:73], v[24:25]
    s_nop 0
    s_cmp_eq_u64 vcc, exec
    s_cbranch_scc1 L_ok_5
    s_mov_b32 s100, 0
    L_lp_6:
    buffer_load_dwordx2 v[24:25], v23, s[56:59], s14 offen sc1
    s_waitcnt vmcnt(0)
    v_cmp_eq_u64 vcc, s[72:73], v[24:25]
    s_add_u32 s100, s100, 1
    s_nop 1
    s_cmp_eq_u64 vcc, exec
    s_cbranch_scc1 L_ok_5
    s_sleep 4
    s_cmp_lt_u32 s100, 200000
    s_cbranch_scc1 L_lp_6
L_ok_5:
    s_waitcnt lgkmcnt(0)
    s_barrier
    v_mfma_f32_32x32x16_bf16 v[128:143], v[56:59], v[72:75], v[128:143]
    ds_read_b128 v[48:51], v16 offset:16384
    ds_read_b64_tr_b16 v[32:33], v10 offset:16384
    s_lshr_b32 s5, s88, 1
    s_lshl_b32 s6, s89, 1
    s_add_u32 s5, s5, s6
    s_lshl_b32 s5, s5, 12
    s_add_u32 s5, s5, 9437184
    v_mfma_f32_32x32x16_bf16 v[144:159], v[56:59], v[76:79], v[144:159]
    ds_read_b64_tr_b16 v[34:35], v10 offset:18432
    ds_read_b128 v[52:55], v16 offset:20480
    buffer_load_dwordx4 v[112:115], v1, s[56:59], s5 offen offset:0 sc1
    buffer_load_dwordx4 v[116:119], v1, s[56:59], s5 offen offset:1024 sc1
    buffer_load_dwordx4 v[120:123], v1, s[56:59], s5 offen offset:2048 sc1
    buffer_load_dwordx4 v[124:127], v1, s[56:59], s5 offen offset:3072 sc1
    v_mfma_f32_32x32x16_bf16 v[160:175], v[60:63], v[72:75], v[160:175]
    ds_read_b64_tr_b16 v[36:37], v11 offset:16384
    ds_read_b64_tr_b16 v[38:39], v11 offset:18432
    v_alignbyte_b32 v107, v89, v88, 2
    v_alignbyte_b32 v108, v90, v89, 2
    v_alignbyte_b32 v109, v91, v90, 2
    v_mfma_f32_32x32x16_bf16 v[176:191], v[60:63], v[76:79], v[176:191]
    ds_read_b64_tr_b16 v[40:41], v12 offset:16384
    ds_read_b64_tr_b16 v[42:43], v12 offset:18432
    ds_write_b128 v111, v[98:101] offset:1024
    ds_write_b128 v111, v[102:105] offset:3392
    ds_write_b128 v111, v[106:109] offset:5760
    v_mfma_f32_32x32x16_bf16 v[192:207], v[64:67], v[72:75], v[192:207]
    ds_read_b64_tr_b16 v[44:45], v13 offset:16384
    ds_read_b64_tr_b16 v[46:47], v13 offset:18432
    ds_write_b128 v111, v[88:91] offset:8128
    v_alignbyte_b32 v98, v93, v92, 2
    v_alignbyte_b32 v99, v94, v93, 2
    v_mfma_f32_32x32x16_bf16 v[208:223], v[64:67], v[76:79], v[208:223]
    ds_read_b64_tr_b16 a[72:73], v20 offset:34816
    s_waitcnt lgkmcnt(14)
    ds_read_b64_tr_b16 a[74:75], v20 offset:35840
    s_waitcnt lgkmcnt(14)
    ds_read_b64_tr_b16 a[76:77], v21 offset:34816
    s_waitcnt lgkmcnt(14)
    ds_read_b64_tr_b16 a[78:79], v21 offset:35840
    v_alignbyte_b32 v100, v95, v94, 2
    v_mfma_f32_32x32x16_bf16 v[224:239], v[68:71], v[72:75], v[224:239]
    v_alignbyte_b32 v101, v96, v95, 2
    v_mov_b32 v102, v93
    v_mov_b32 v103, v94
    v_mov_b32 v104, v95
    v_mov_b32 v105, v96
    v_alignbyte_b32 v106, v94, v93, 2
    v_mfma_f32_32x32x16_bf16 v[240:255], v[68:71], v[76:79], v[240:255]
    v_alignbyte_b32 v107, v95, v94, 2
    v_alignbyte_b32 v108, v96, v95, 2
    v_alignbyte_b32 v109, v97, v96, 2
    s_mov_b64 exec, 0xff
    s_waitcnt lgkmcnt(14)
    ds_write_b128 v111, v[98:101] offset:2048
    s_waitcnt lgkmcnt(14)
    ds_write_b128 v111, v[102:105] offset:4416
    s_waitcnt lgkmcnt(14)
    ds_write_b128 v111, v[106:109] offset:6784
    s_waitcnt lgkmcnt(14)
    ds_write_b128 v111, v[94:97] offset:9152
    s_mov_b64 exec, -1
    v_mfma_f32_32x32x16_bf16 v[128:143], v[32:35], v[48:51], v[128:143]
    s_waitcnt lgkmcnt(14)
    ds_read_b128 v[72:75], v17 offset:16384
    s_waitcnt lgkmcnt(14)
    ds_read_b64_tr_b16 v[56:57], v10 offset:24576
    s_lshl_b32 s5, s97, 3
    s_add_u32 s5, s5, s98
    s_lshl_b32 s5, s5, 2
    s_add_u32 s5, s5, s88
    s_lshl_b32 s5, s5, 11
    v_mfma_f32_32x32x16_bf16 v[144:159], v[32:35], v[52:55], v[144:159]
    s_waitcnt lgkmcnt(14)
    ds_read_b64_tr_b16 v[58:59], v10 offset:26624
    s_waitcnt lgkmcnt(14)
    ds_read_b128 v[76:79], v17 offset:20480
    global_load_dwordx4 v[98:101], v1, s[36:37]
    buffer_load_dwordx4 v[102:105], v1, s[44:47], s5 offen offset:0
    buffer_load_dwordx4 v[106:109], v1, s[44:47], s5 offen offset:1024
    v_mfma_f32_32x32x16_bf16 v[160:175], v[36:39], v[48:51], v[160:175]
    s_waitcnt lgkmcnt(14)
    ds_read_b64_tr_b16 v[60:61], v11 offset:24576
    s_waitcnt lgkmcnt(14)
    ds_read_b64_tr_b16 v[62:63], v11 offset:26624
    v_mfma_f32_32x32x16_bf16 v[176:191], v[36:39], v[52:55], v[176:191]
    s_waitcnt lgkmcnt(14)
    ds_read_b64_tr_b16 v[64:65], v12 offset:24576
    s_waitcnt lgkmcnt(14)
    ds_read_b64_tr_b16 v[66:67], v12 offset:26624
    v_mfma_f32_32x32x16_bf16 v[192:207], v[40:43], v[48:51], v[192:207]
    s_waitcnt lgkmcnt(14)
    ds_read_b64_tr_b16 v[68:69], v13 offset:24576
    s_waitcnt lgkmcnt(14)
    ds_read_b64_tr_b16 v[70:71], v13 offset:26624
    v_mfma_f32_32x32x16_bf16 v[208:223], v[40:43], v[52:55], v[208:223]
    v_mfma_f32_32x32x16_bf16 v[224:239], v[44:47], v[48:51], v[224:239]
    v_mfma_f32_32x32x16_bf16 v[240:255], v[44:47], v[52:55], v[240:255]
    s_waitcnt lgkmcnt(0)
    s_barrier
    v_mfma_f32_32x32x16_bf16 v[128:143], v[56:59], v[72:75], v[128:143]
    v_mfma_f32_32x32x16_bf16 v[144:159], v[56:59], v[76:79], v[144:159]
    v_mfma_f32_32x32x16_bf16 v[160:175], v[60:63], v[72:75], v[160:175]
    v_mfma_f32_32x32x16_bf16 v[176:191], v[60:63], v[76:79], v[176:191]
    s_and_b32 s5, s88, 1
    s_mul_i32 s7, s5, 2304
    s_lshl_b32 s6, s88, 14
    s_add_u32 s6, s6, 44208
    s_add_u32 s6, s6, s7
    v_lshrrev_b32 v30, 3, v0
    v_mul_u32_u24 v30, 144, v30
    v_and_b32 v31, 7, v0
    v_lshl_add_u32 v30, v31, 4, v30
    v_add_u32 v110, s6, v30
    v_mfma_f32_32x32x16_bf16 v[192:207], v[64:67], v[72:75], v[192:207]
    s_sub_u32 s7, 2304, s7
    v_add_u32 v111, s7, v110
    s_waitcnt vmcnt(4)
    ds_write_b128 v111, v[120:123] offset:0
    s_waitcnt vmcnt(3)
    ds_write_b128 v111, v[124:127] offset:1152
    ds_write_b128 v110, v[112:115] offset:0
    ds_write_b128 v110, v[116:119] offset:1152
    v_mfma_f32_32x32x16_bf16 v[208:223], v[64:67], v[76:79], v[208:223]
    v_mfma_f32_32x32x16_bf16 v[224:239], v[68:71], v[72:75], v[224:239]
    v_mfma_f32_32x32x16_bf16 v[240:255], v[68:71], v[76:79], v[240:255]
L_join:
    ds_read_b64 v[32:33], v18 offset:0
    ds_read_b64 v[34:35], v18 offset:8
    ds_read_b128 v[56:59], v19 offset:2256
    ds_read_b64 v[40:41], v18 offset:64
    ds_read_b64 v[42:43], v18 offset:72
    ds_read_b64 v[36:37], v18 offset:32
    ds_read_b64 v[38:39], v18 offset:40
    ds_read_b128 v[60:63], v19 offset:2224
    ds_read_b64 v[44:45], v18 offset:96
    ds_read_b64 v[46:47], v18 offset:104
    s_waitcnt lgkmcnt(7)
    v_mfma_f32_32x32x16_bf16 a[224:239], v[32:35], v[56:59], 0
    ds_read_b128 v[64:67], v19 offset:2192
    ds_read_b64 v[48:49], v18 offset:128
    s_waitcnt lgkmcnt(7)
    v_mfma_f32_32x32x16_bf16 a[240:255], v[40:43], v[56:59], 0
    ds_read_b64 v[50:51], v18 offset:136
    v_max_f32 v128, 0, v128
    v_max_f32 v129, 0, v129
    v_max_f32 v130, 0, v130
    v_max_f32 v131, 0, v131
    v_mul_f32 v128, v128, v132
    v_mul_f32 v129, v129, v133
    v_mul_f32 v130, v130, v134
    v_mul_f32 v131, v131, v135
    v_max_f32 v136, 0, v136
    v_max_f32 v137, 0, v137
    s_waitcnt lgkmcnt(5)
    v_mfma_f32_32x32x16_bf16 a[224:239], v[36:39], v[60:63], a[224:239]
    ds_read_b128 v[68:71], v19 offset:2160
    ds_read_b64 v[52:53], v18 offset:160
    v_max_f32 v138, 0, v138
    v_max_f32 v139, 0, v139
    v_mul_f32 v136, v136, v140
    v_mul_f32 v137, v137, v141
    v_mul_f32 v138, v138, v142
    v_mul_f32 v139, v139, v143
    v_cvt_pk_bf16_f32 v132, v128, v129
    v_cvt_pk_bf16_f32 v133, v130, v131
    s_waitcnt lgkmcnt(5)
    v_mfma_f32_32x32x16_bf16 a[240:255], v[44:47], v[60:63], a[240:255]
    ds_read_b64 v[54:55], v18 offset:168
    v_cvt_pk_bf16_f32 v134, v136, v137
    v_cvt_pk_bf16_f32 v135, v138, v139
    buffer_store_dwordx4 v[132:135], v1, s[60:63], s95 offen offset:0 sc1
    v_max_f32 v144, 0, v144
    v_max_f32 v145, 0, v145
    v_max_f32 v146, 0, v146
    v_max_f32 v147, 0, v147
    v_mul_f32 v144, v144, v148
    v_mul_f32 v145, v145, v149
    s_waitcnt lgkmcnt(5)
    v_mfma_f32_32x32x16_bf16 a[224:239], v[40:43], v[64:67], a[224:239]
    ds_read_b128 v[56:59], v19 offset:2112
    ds_read_b64 v[32:33], v18 offset:192
    v_mul_f32 v146, v146, v150
    v_mul_f32 v147, v147, v151
    v_max_f32 v152, 0, v152
    v_max_f32 v153, 0, v153
    v_max_f32 v154, 0, v154
    v_max_f32 v155, 0, v155
    v_mul_f32 v152, v152, v156
    v_mul_f32 v153, v153, v157
    s_waitcnt lgkmcnt(5)
    v_mfma_f32_32x32x16_bf16 a[240:255], v[48:51], v[64:67], a[240:255]
    ds_read_b64 v[34:35], v18 offset:200
    v_mul_f32 v154, v154, v158
    v_mul_f32 v155, v155, v159
    v_cvt_pk_bf16_f32 v148, v144, v145
    v_cvt_pk_bf16_f32 v149, v146, v147
    v_cvt_pk_bf16_f32 v150, v152, v153
    v_cvt_pk_bf16_f32 v151, v154, v155
    buffer_store_dwordx4 v[148:151], v1, s[60:63], s95 offen offset:1024 sc1
    v_max_f32 v160, 0, v160
    s_waitcnt lgkmcnt(5)
    v_mfma_f32_32x32x16_bf16 a[224:239], v[44:47], v[68:71], a[224:239]
    ds_read_b128 v[60:63], v19 offset:2080
    ds_read_b64 v[36:37], v18 offset:224
    v_max_f32 v161, 0, v161
    v_max_f32 v162, 0, v162
    v_max_f32 v163, 0, v163
    v_mul_f32 v160, v160, v164
    v_mul_f32 v161, v161, v165
    v_mul_f32 v162, v162, v166
    v_mul_f32 v163, v163, v167
    v_max_f32 v168, 0, v168
    s_waitcnt lgkmcnt(5)
    v_mfma_f32_32x32x16_bf16 a[240:255], v[52:55], v[68:71], a[240:255]
    ds_read_b64 v[38:39], v18 offset:232
    v_max_f32 v169, 0, v169
    v_max_f32 v170, 0, v170
    v_max_f32 v171, 0, v171
    v_mul_f32 v168, v168, v172
    v_mul_f32 v169, v169, v173
    v_mul_f32 v170, v170, v174
    v_mul_f32 v171, v171, v175
    v_cvt_pk_bf16_f32 v164, v160, v161
    v_cvt_pk_bf16_f32 v165, v162, v163
    s_waitcnt lgkmcnt(5)
    v_mfma_f32_32x32x16_bf16 a[224:239], v[48:51], v[56:59], a[224:239]
    ds_read_b128 v[64:67], v19 offset:2048
    ds_read_b64 v[40:41], v18 offset:256
    v_cvt_pk_bf16_f32 v166, v168, v169
    v_cvt_pk_bf16_f32 v167, v170, v171
    buffer_store_dwordx4 v[164:167], v1, s[60:63], s95 offen offset:2048 sc1
    v_max_f32 v176, 0, v176
    v_max_f32 v177, 0, v177
    v_max_f32 v178, 0, v178
    v_max_f32 v179, 0, v179
    v_mul_f32 v176, v176, v180
    s_waitcnt lgkmcnt(5)
    v_mfma_f32_32x32x16_bf16 a[240:255], v[32:35], v[56:59], a[240:255]
    ds_read_b64 v[42:43], v18 offset:264
    v_mul_f32 v177, v177, v181
    v_mul_f32 v178, v178, v182
    v_mul_f32 v179, v179, v183
    v_max_f32 v184, 0, v184
    v_max_f32 v185, 0, v185
    v_max_f32 v186, 0, v186
    v_max_f32 v187, 0, v187
    v_mul_f32 v184, v184, v188
    v_mul_f32 v185, v185, v189
    v_mul_f32 v186, v186, v190
    s_waitcnt lgkmcnt(5)
    v_mfma_f32_32x32x16_bf16 a[224:239], v[52:55], v[60:63], a[224:239]
    ds_read_b128 v[68:71], v19 offset:2016
    ds_read_b64 v[44:45], v18 offset:288
    v_mul_f32 v187, v187, v191
    v_cvt_pk_bf16_f32 v180, v176, v177
    v_cvt_pk_bf16_f32 v181, v178, v179
    v_cvt_pk_bf16_f32 v182, v184, v185
    v_cvt_pk_bf16_f32 v183, v186, v187
    buffer_store_dwordx4 v[180:183], v1, s[60:63], s95 offen offset:3072 sc1
    v_max_f32 v192, 0, v192
    s_waitcnt lgkmcnt(5)
    v_mfma_f32_32x32x16_bf16 a[240:255], v[36:39], v[60:63], a[240:255]
    ds_read_b64 v[46:47], v18 offset:296
    v_max_f32 v193, 0, v193
    v_max_f32 v194, 0, v194
    v_max_f32 v195, 0, v195
    v_mul_f32 v192, v192, v196
    v_mul_f32 v193, v193, v197
    v_mul_f32 v194, v194, v198
    v_mul_f32 v195, v195, v199
    v_max_f32 v200, 0, v200
    v_max_f32 v201, 0, v201
    v_max_f32 v202, 0, v202
    s_waitcnt lgkmcnt(5)
    v_mfma_f32_32x32x16_bf16 a[224:239], v[32:35], v[64:67], a[224:239]
    ds_read_b128 v[56:59], v19 offset:1968
    ds_read_b64 v[48:49], v18 offset:320
    v_max_f32 v203, 0, v203
    v_mul_f32 v200, v200, v204
    v_mul_f32 v201, v201, v205
    v_mul_f32 v202, v202, v206
    v_mul_f32 v203, v203, v207
    v_cvt_pk_bf16_f32 v196, v192, v193
    v_cvt_pk_bf16_f32 v197, v194, v195
    v_cvt_pk_bf16_f32 v198, v200, v201
    s_waitcnt lgkmcnt(5)
    v_mfma_f32_32x32x16_bf16 a[240:255], v[40:43], v[64:67], a[240:255]
    ds_read_b64 v[50:51], v18 offset:328
    v_cvt_pk_bf16_f32 v199, v202, v203
    s_add_u32 s95, s95, 4096
    buffer_store_dwordx4 v[196:199], v1, s[60:63], s95 offen offset:0 sc1
    v_max_f32 v208, 0, v208
    v_max_f32 v209, 0, v209
    v_max_f32 v210, 0, v210
    v_max_f32 v211, 0, v211
    v_mul_f32 v208, v208, v212
    v_mul_f32 v209, v209, v213
    s_waitcnt lgkmcnt(5)
    v_mfma_f32_32x32x16_bf16 a[224:239], v[36:39], v[68:71], a[224:239]
    ds_read_b128 v[60:63], v19 offset:1936
    ds_read_b64 v[52:53], v18 offset:352
    v_mul_f32 v210, v210, v214
    v_mul_f32 v211, v211, v215
    v_max_f32 v216, 0, v216
    v_max_f32 v217, 0, v217
    v_max_f32 v218, 0, v218
    v_max_f32 v219, 0, v219
    v_mul_f32 v216, v216, v220
    v_mul_f32 v217, v217, v221
    s_waitcnt lgkmcnt(5)
    v_mfma_f32_32x32x16_bf16 a[240:255], v[44:47], v[68:71], a[240:255]
    ds_read_b64 v[54:55], v18 offset:360
    v_mul_f32 v218, v218, v222
    v_mul_f32 v219, v219, v223
    v_cvt_pk_bf16_f32 v212, v208, v209
    v_cvt_pk_bf16_f32 v213, v210, v211
    v_cvt_pk_bf16_f32 v214, v216, v217
    v_cvt_pk_bf16_f32 v215, v218, v219
    buffer_store_dwordx4 v[212:215], v1, s[60:63], s95 offen offset:1024 sc1
    v_max_f32 v224, 0, v224
    s_waitcnt lgkmcnt(5)
    v_mfma_f32_32x32x16_bf16 a[224:239], v[40:43], v[56:59], a[224:239]
    ds_read_b128 v[64:67], v19 offset:1904
    ds_read_b64 v[32:33], v18 offset:384
    v_max_f32 v225, 0, v225
    v_max_f32 v226, 0, v226
    v_max_f32 v227, 0, v227
    v_mul_f32 v224, v224, v228
    v_mul_f32 v225, v225, v229
    v_mul_f32 v226, v226, v230
    v_mul_f32 v227, v227, v231
    v_max_f32 v232, 0, v232
    s_waitcnt lgkmcnt(5)
    v_mfma_f32_32x32x16_bf16 a[240:255], v[48:51], v[56:59], a[240:255]
    ds_read_b64 v[34:35], v18 offset:392
    v_max_f32 v233, 0, v233
    v_max_f32 v234, 0, v234
    v_max_f32 v235, 0, v235
    v_mul_f32 v232, v232, v236
    v_mul_f32 v233, v233, v237
    v_mul_f32 v234, v234, v238
    v_mul_f32 v235, v235, v239
    v_cvt_pk_bf16_f32 v228, v224, v225
    v_cvt_pk_bf16_f32 v229, v226, v227
    s_waitcnt lgkmcnt(5)
    v_mfma_f32_32x32x16_bf16 a[224:239], v[44:47], v[60:63], a[224:239]
    ds_read_b128 v[68:71], v19 offset:1872
    ds_read_b64 v[36:37], v18 offset:416
    v_cvt_pk_bf16_f32 v230, v232, v233
    v_cvt_pk_bf16_f32 v231, v234, v235
    buffer_store_dwordx4 v[228:231], v1, s[60:63], s95 offen offset:2048 sc1
    v_max_f32 v240, 0, v240
    v_max_f32 v241, 0, v241
    v_max_f32 v242, 0, v242
    v_max_f32 v243, 0, v243
    v_mul_f32 v240, v240, v244
    s_waitcnt lgkmcnt(5)
    v_mfma_f32_32x32x16_bf16 a[240:255], v[52:55], v[60:63], a[240:255]
    ds_read_b64 v[38:39], v18 offset:424
    v_mul_f32 v241, v241, v245
    v_mul_f32 v242, v242, v246
    v_mul_f32 v243, v243, v247
    v_max_f32 v248, 0, v248
    v_max_f32 v249, 0, v249
    v_max_f32 v250, 0, v250
    v_max_f32 v251, 0, v251
    v_mul_f32 v248, v248, v252
    v_mul_f32 v249, v249, v253
    v_mul_f32 v250, v250, v254
    s_waitcnt lgkmcnt(5)
    v_mfma_f32_32x32x16_bf16 a[224:239], v[48:51], v[64:67], a[224:239]
    ds_read_b128 v[56:59], v19 offset:1824
    ds_read_b64 v[40:41], v18 offset:448
    v_mul_f32 v251, v251, v255
    v_cvt_pk_bf16_f32 v244, v240, v241
    v_cvt_pk_bf16_f32 v245, v242, v243
    v_cvt_pk_bf16_f32 v246, v248, v249
    v_cvt_pk_bf16_f32 v247, v250, v251
    buffer_store_dwordx4 v[244:247], v1, s[60:63], s95 offen offset:3072 sc1
    s_waitcnt lgkmcnt(5)
    v_mfma_f32_32x32x16_bf16 a[240:255], v[32:35], v[64:67], a[240:255]
    ds_read_b64 v[42:43], v18 offset:456
    ds_read_b64_tr_b16 a[80:81], v20 offset:36864
    ds_read_b64_tr_b16 a[82:83], v20 offset:37888
    s_waitcnt vmcnt(9)
    v_dot2_f32_bf16 v102, v102, v98, 0
    s_waitcnt lgkmcnt(7)
    v_mfma_f32_32x32x16_bf16 a[224:239], v[52:55], v[68:71], a[224:239]
    ds_read_b128 v[60:63], v19 offset:1792
    ds_read_b64 v[44:45], v18 offset:480
    ds_read_b64_tr_b16 a[84:85], v21 offset:36864
    ds_read_b64_tr_b16 a[86:87], v21 offset:37888
    ds_read_b64_tr_b16 a[88:89], v20 offset:38912
    ds_read_b64_tr_b16 a[90:91], v20 offset:39936
    s_waitcnt lgkmcnt(11)
    v_mfma_f32_32x32x16_bf16 a[240:255], v[36:39], v[68:71], a[240:255]
    ds_read_b64 v[46:47], v18 offset:488
    ds_read_b64_tr_b16 a[92:93], v21 offset:38912
    ds_read_b64_tr_b16 a[94:95], v21 offset:39936
    v_dot2_f32_bf16 v102, v103, v99, v102
    s_waitcnt lgkmcnt(13)
    v_mfma_f32_32x32x16_bf16 a[224:239], v[32:35], v[56:59], a[224:239]
    ds_read_b128 v[64:67], v19 offset:1760
    ds_read_b64 v[48:49], v18 offset:512
    v_dot2_f32_bf16 v102, v104, v100, v102
    v_dot2_f32_bf16 v102, v105, v101, v102
    s_waitcnt lgkmcnt(13)
    v_mfma_f32_32x32x16_bf16 a[240:255], v[40:43], v[56:59], a[240:255]
    ds_read_b64 v[50:51], v18 offset:520
    s_waitcnt vmcnt(8)
    v_dot2_f32_bf16 v106, v106, v98, 0
    v_dot2_f32_bf16 v106, v107, v99, v106
    v_dot2_f32_bf16 v106, v108, v100, v106
    s_waitcnt lgkmcnt(11)
    v_mfma_f32_32x32x16_bf16 a[224:239], v[36:39], v[60:63], a[224:239]
    ds_read_b128 v[68:71], v19 offset:1728
    ds_read_b64 v[52:53], v18 offset:544
    v_dot2_f32_bf16 v106, v109, v101, v106
    s_nop 2
    v_permlane32_swap_b32 v102, v106
    v_add_f32 v102, v102, v106
    s_waitcnt lgkmcnt(7)
    v_mfma_f32_32x32x16_bf16 a[240:255], v[44:47], v[60:63], a[240:255]
    ds_read_b64 v[54:55], v18 offset:552
    v_mov_b32 v103, v102
    s_nop 1
    v_permlane16_swap_b32 v102, v103
    v_add_f32 v102, v102, v103
    s_nop 1
    v_add_f32_dpp v102, v102, v102 row_ror:8 row_mask:0xf bank_mask:0xf
    s_waitcnt lgkmcnt(5)
    v_mfma_f32_32x32x16_bf16 a[224:239], v[40:43], v[64:67], a[224:239]
    ds_read_b128 v[56:59], v19 offset:1680
    ds_read_b64 v[32:33], v18 offset:576
    s_lshl_b32 s96, s80, 3
    s_add_u32 m0, s29, 0
    s_nop 0
    buffer_load_dwordx4 v22, s[68:71], s96 offen offset:0  lds
    s_add_u32 s96, s96, 7168
    buffer_load_dwordx4 v22, s[68:71], s96 offen offset:1024  lds
    s_waitcnt lgkmcnt(5)
    v_mfma_f32_32x32x16_bf16 a[240:255], v[48:51], v[64:67], a[240:255]
    ds_read_b64 v[34:35], v18 offset:584
    v_add_f32_dpp v102, v102, v102 row_ror:4 row_mask:0xf bank_mask:0xf
    s_nop 1
    v_add_f32_dpp v102, v102, v102 row_ror:2 row_mask:0xf bank_mask:0xf
    s_nop 1
    v_add_f32_dpp v102, v102, v102 row_ror:1 row_mask:0xf bank_mask:0xf
    s_waitcnt lgkmcnt(5)
    v_mfma_f32_32x32x16_bf16 a[224:239], v[44:47], v[68:71], a[224:239]
    ds_read_b128 v[60:63], v19 offset:1648
    ds_read_b64 v[36:37], v18 offset:608
    v_cvt_pk_bf16_f32 v102, v102, v102
    v_and_b32 v102, s99, v102
    s_waitcnt lgkmcnt(5)
    v_mfma_f32_32x32x16_bf16 a[240:255], v[52:55], v[68:71], a[240:255]
    ds_read_b64 v[38:39], v18 offset:616
    s_add_u32 s96, s96, 9216
    s_add_u32 m0, s29, 2048
    s_nop 0
    buffer_load_dwordx4 v22, s[68:71], s96 offen offset:0  lds
    s_add_u32 s96, s96, 7168
    buffer_load_dwordx4 v22, s[68:71], s96 offen offset:1024  lds
    s_waitcnt lgkmcnt(5)
    v_mfma_f32_32x32x16_bf16 a[224:239], v[48:51], v[56:59], a[224:239]
    ds_read_b128 v[64:67], v19 offset:1616
    ds_read_b64 v[40:41], v18 offset:640
    v_mul_f32 v102, 0xbfb8aa3b, v102
    v_exp_f32 v102, v102
    s_waitcnt lgkmcnt(5)
    v_mfma_f32_32x32x16_bf16 a[240:255], v[32:35], v[56:59], a[240:255]
    ds_read_b64 v[42:43], v18 offset:648
    v_add_f32 v102, 1.0, v102
    v_rcp_f32 v102, v102
    s_nop 0
    v_cvt_pk_bf16_f32 v102, v102, v102
    s_waitcnt lgkmcnt(5)
    v_mfma_f32_32x32x16_bf16 a[224:239], v[52:55], v[60:63], a[224:239]
    ds_read_b128 v[68:71], v19 offset:1584
    ds_read_b64 v[44:45], v18 offset:672
    v_and_b32 v102, s99, v102
    v_sub_f32 v103, 1.0, v102
    v_cvt_pk_bf16_f32 v102, v102, v103
    s_waitcnt lgkmcnt(5)
    v_mfma_f32_32x32x16_bf16 a[240:255], v[36:39], v[60:63], a[240:255]
    ds_read_b64 v[46:47], v18 offset:680
    s_lshl_b32 s96, s81, 3
    s_add_u32 m0, s29, 4096
    s_nop 0
    buffer_load_dwordx4 v22, s[68:71], s96 offen offset:0  lds
    s_add_u32 s96, s96, 7168
    buffer_load_dwordx4 v22, s[68:71], s96 offen offset:1024  lds
    s_waitcnt lgkmcnt(5)
    v_mfma_f32_32x32x16_bf16 a[224:239], v[32:35], v[64:67], a[224:239]
    ds_read_b128 v[56:59], v19 offset:1536
    ds_read_b64 v[48:49], v18 offset:704
    v_mov_b32 v103, s72
    v_lshrrev_b32 v104, 5, v0
    v_lshlrev_b32 v104, 3, v104
    s_waitcnt lgkmcnt(5)
    v_mfma_f32_32x32x16_bf16 a[240:255], v[40:43], v[64:67], a[240:255]
    ds_read_b64 v[50:51], v18 offset:712
    s_lshl_b32 s5, s97, 3
    s_add_u32 s5, s5, s98
    s_lshl_b32 s5, s5, 2
    s_add_u32 s5, s5, s88
    s_waitcnt lgkmcnt(5)
    v_mfma_f32_32x32x16_bf16 a[224:239], v[36:39], v[68:71], a[224:239]
    ds_read_b128 v[60:63], v19 offset:1504
    ds_read_b64 v[52:53], v18 offset:736
    s_add_u32 s96, s96, 9216
    s_add_u32 m0, s29, 6144
    s_nop 0
    buffer_load_dwordx4 v22, s[68:71], s96 offen offset:0  lds
    s_add_u32 s96, s96, 7168
    buffer_load_dwordx4 v22, s[68:71], s96 offen offset:1024  lds
    s_waitcnt lgkmcnt(5)
    v_mfma_f32_32x32x16_bf16 a[240:255], v[44:47], v[68:71], a[240:255]
    ds_read_b64 v[54:55], v18 offset:744
    s_lshl_b32 s5, s5, 4
    s_add_u32 s5, s5, 13631488
    s_mov_b32 exec_lo, 1
    s_mov_b32 exec_hi, 1
    buffer_store_dwordx2 v[102:103], v104, s[56:59], s5 offen sc1
    s_mov_b64 exec, -1
    s_waitcnt lgkmcnt(5)
    v_mfma_f32_32x32x16_bf16 a[224:239], v[40:43], v[56:59], a[224:239]
    ds_read_b128 v[64:67], v19 offset:1472
    ds_read_b64 v[32:33], v18 offset:768
    s_waitcnt lgkmcnt(5)
    v_mfma_f32_32x32x16_bf16 a[240:255], v[48:51], v[56:59], a[240:255]
    ds_read_b64 v[34:35], v18 offset:776
    s_waitcnt lgkmcnt(5)
    v_mfma_f32_32x32x16_bf16 a[224:239], v[44:47], v[60:63], a[224:239]
    ds_read_b128 v[68:71], v19 offset:1440
    ds_read_b64 v[36:37], v18 offset:800
    s_lshl_b32 s96, s82, 3
    s_add_u32 m0, s29, 32768
    s_nop 0
    buffer_load_dwordx4 v22, s[68:71], s96 offen offset:0  lds
    s_add_u32 s96, s96, 7168
    buffer_load_dwordx4 v22, s[68:71], s96 offen offset:1024  lds
    s_waitcnt lgkmcnt(5)
    v_mfma_f32_32x32x16_bf16 a[240:255], v[52:55], v[60:63], a[240:255]
    ds_read_b64 v[38:39], v18 offset:808
    s_waitcnt lgkmcnt(5)
    v_mfma_f32_32x32x16_bf16 a[224:239], v[48:51], v[64:67], a[224:239]
    ds_read_b128 v[56:59], v19 offset:1392
    ds_read_b64 v[40:41], v18 offset:832
    v_mov_b32 v28, 0
    s_waitcnt vmcnt(11)
    s_mov_b64 exec, 1
    buffer_store_dwordx2 v[26:27], v28, s[60:63], s13 offen sc1
    s_mov_b64 exec, -1
    s_waitcnt lgkmcnt(5)
    v_mfma_f32_32x32x16_bf16 a[240:255], v[32:35], v[64:67], a[240:255]
    ds_read_b64 v[42:43], v18 offset:840
    s_add_u32 s96, s96, 9216
    s_add_u32 m0, s29, 34816
    s_nop 0
    buffer_load_dwordx4 v22, s[68:71], s96 offen offset:0  lds
    s_add_u32 s96, s96, 7168
    buffer_load_dwordx4 v22, s[68:71], s96 offen offset:1024  lds
    s_waitcnt lgkmcnt(5)
    v_mfma_f32_32x32x16_bf16 a[224:239], v[52:55], v[68:71], a[224:239]
    ds_read_b128 v[60:63], v19 offset:1360
    ds_read_b64 v[44:45], v18 offset:864
    s_xor_b32 s5, s88, 2
    s_mul_i32 s5, s5, 6144
    v_add_u32 v154, s5, v1
    s_waitcnt lgkmcnt(5)
    v_mfma_f32_32x32x16_bf16 a[240:255], v[36:39], v[68:71], a[240:255]
    ds_read_b64 v[46:47], v18 offset:872
    s_xor_b32 s5, s88, 1
    s_mul_i32 s5, s5, 6144
    v_add_u32 v155, s5, v1
    s_xor_b32 s5, s88, 3
    s_waitcnt lgkmcnt(5)
    v_mfma_f32_32x32x16_bf16 a[224:239], v[32:35], v[56:59], a[224:239]
    ds_read_b128 v[64:67], v19 offset:1328
    ds_read_b64 v[48:49], v18 offset:896
    s_mul_i32 s5, s5, 6144
    v_add_u32 v156, s5, v1
    s_mul_i32 s5, s88, 6144
    s_waitcnt lgkmcnt(5)
    v_mfma_f32_32x32x16_bf16 a[240:255], v[40:43], v[56:59], a[240:255]
    ds_read_b64 v[50:51], v18 offset:904
    s_lshl_b32 s96, s83, 3
    s_add_u32 m0, s29, 36864
    s_nop 0
    buffer_load_dwordx4 v22, s[68:71], s96 offen offset:0  lds
    s_add_u32 s96, s96, 7168
    buffer_load_dwordx4 v22, s[68:71], s96 offen offset:1024  lds
    s_waitcnt lgkmcnt(5)
    v_mfma_f32_32x32x16_bf16 a[224:239], v[36:39], v[60:63], a[224:239]
    ds_read_b128 v[68:71], v19 offset:1296
    ds_read_b64 v[52:53], v18 offset:928
    v_add_u32 v157, s5, v1
    s_waitcnt lgkmcnt(5)
    v_mfma_f32_32x32x16_bf16 a[240:255], v[44:47], v[60:63], a[240:255]
    ds_read_b64 v[54:55], v18 offset:936
    s_lshl_b32 s6, s88, 14
    s_add_u32 s6, s6, 32768
    v_and_b32 v30, 31, v0
    v_mul_u32_u24 v30, 272, v30
    s_waitcnt lgkmcnt(5)
    v_mfma_f32_32x32x16_bf16 a[224:239], v[40:43], v[64:67], a[224:239]
    ds_read_b128 v[56:59], v19 offset:1248
    ds_read_b64 v[32:33], v18 offset:960
    s_add_u32 s96, s96, 9216
    s_add_u32 m0, s29, 38912
    s_nop 0
    buffer_load_dwordx4 v22, s[68:71], s96 offen offset:0  lds
    s_add_u32 s96, s96, 7168
    buffer_load_dwordx4 v22, s[68:71], s96 offen offset:1024  lds
    s_waitcnt lgkmcnt(5)
    v_mfma_f32_32x32x16_bf16 a[240:255], v[48:51], v[64:67], a[240:255]
    ds_read_b64 v[34:35], v18 offset:968
    v_lshrrev_b32 v31, 5, v0
    v_lshl_add_u32 v30, v31, 4, v30
    v_add_u32 v30, s6, v30
    s_and_b32 s5, s88, 2
    s_waitcnt lgkmcnt(5)
    v_mfma_f32_32x32x16_bf16 a[224:239], v[44:47], v[68:71], a[224:239]
    ds_read_b128 v[60:63], v19 offset:1216
    ds_read_b64 v[36:37], v18 offset:992
    s_lshl_b32 s5, s5, 14
    s_add_u32 s5, s5, 32768
    s_and_b32 s7, s88, 1
    s_waitcnt lgkmcnt(5)
    v_mfma_f32_32x32x16_bf16 a[240:255], v[52:55], v[68:71], a[240:255]
    ds_read_b64 v[38:39], v18 offset:1000
    s_lshl_b32 s7, s7, 4
    v_lshrrev_b32 v28, 3, v0
    v_add_u32 v28, s7, v28
    v_and_b32 v29, 7, v0
    s_waitcnt lgkmcnt(5)
    v_mfma_f32_32x32x16_bf16 a[224:239], v[48:51], v[56:59], a[224:239]
    ds_read_b128 v[64:67], v19 offset:1184
    ds_read_b64 v[40:41], v18 offset:1024
    v_mul_u32_u24 v31, 272, v28
    v_lshl_add_u32 v31, v29, 5, v31
    s_waitcnt lgkmcnt(5)
    v_mfma_f32_32x32x16_bf16 a[240:255], v[32:35], v[56:59], a[240:255]
    ds_read_b64 v[42:43], v18 offset:1032
    v_add_u32 v152, s5, v31
    v_mul_u32_u24 v31, 144, v28
    v_lshl_add_u32 v31, v29, 4, v31
    s_add_u32 s5, s5, 11440
    s_waitcnt lgkmcnt(5)
    v_mfma_f32_32x32x16_bf16 a[224:239], v[52:55], v[60:63], a[224:239]
    ds_read_b128 v[68:71], v19 offset:1152
    ds_read_b64 v[44:45], v18 offset:1056
    v_add_u32 v153, s5, v31
    s_lshr_b32 s5, s88, 1
    s_lshl_b32 s6, s89, 1
    s_waitcnt lgkmcnt(5)
    v_mfma_f32_32x32x16_bf16 a[240:255], v[36:39], v[60:63], a[240:255]
    ds_read_b64 v[46:47], v18 offset:1064
    s_add_u32 s5, s5, s6
    s_and_b32 s7, s88, 1
    s_lshl_b32 s12, s5, 12
    s_lshl_b32 s8, s7, 11
    s_waitcnt lgkmcnt(5)
    v_mfma_f32_32x32x16_bf16 a[224:239], v[32:35], v[64:67], a[224:239]
    ds_read_b128 v[56:59], v19 offset:1104
    ds_read_b64 v[48:49], v18 offset:1088
    s_add_u32 s12, s12, s8
    s_add_u32 s12, s12, 11534336
    s_lshr_b32 s8, s5, 6
    s_waitcnt lgkmcnt(5)
    v_mfma_f32_32x32x16_bf16 a[240:255], v[40:43], v[64:67], a[240:255]
    ds_read_b64 v[50:51], v18 offset:1096
    s_lshl_b32 s8, s8, 1
    s_add_u32 s8, s8, s7
    s_lshl_b32 s8, s8, 13
    s_and_b32 s11, s5, 63
    s_waitcnt lgkmcnt(5)
    v_mfma_f32_32x32x16_bf16 a[224:239], v[36:39], v[68:71], a[224:239]
    ds_read_b128 v[60:63], v19 offset:1072
    ds_read_b64 v[52:53], v18 offset:1120
    s_waitcnt vmcnt(16)
    ds_read_b64_tr_b16 a[96:97], v20 offset:0
    ds_read_b64_tr_b16 a[98:99], v20 offset:1024
    s_waitcnt lgkmcnt(7)
    v_mfma_f32_32x32x16_bf16 a[240:255], v[44:47], v[68:71], a[240:255]
    ds_read_b64 v[54:55], v18 offset:1128
    ds_read_b64_tr_b16 a[100:101], v21 offset:0
    ds_read_b64_tr_b16 a[102:103], v21 offset:1024
    s_waitcnt lgkmcnt(0)
    s_lshl_b32 s96, s84, 3
    s_add_u32 m0, s29, 0
    s_nop 0
    buffer_load_dwordx4 v22, s[68:71], s96 offen offset:0  lds
    s_add_u32 s96, s96, 7168
    buffer_load_dwordx4 v22, s[68:71], s96 offen offset:1024  lds
    v_mfma_f32_32x32x16_bf16 a[224:239], v[40:43], v[56:59], a[224:239]
    ds_read_b128 v[64:67], v19 offset:1040
    ds_read_b64 v[32:33], v18 offset:1152
    s_lshl_b32 s11, s11, 7
    s_add_u32 s11, s11, s8
    s_add_u32 s11, s11, 14155776
    v_mfma_f32_32x32x16_bf16 a[240:255], v[48:51], v[56:59], a[240:255]
    ds_read_b64 v[34:35], v18 offset:1160
    s_waitcnt vmcnt(16)
    ds_read_b64_tr_b16 a[104:105], v20 offset:2048
    ds_read_b64_tr_b16 a[106:107], v20 offset:3072
    v_mfma_f32_32x32x16_bf16 a[224:239], v[44:47], v[60:63], a[224:239]
    ds_read_b128 v[68:71], v19 offset:1008
    ds_read_b64 v[36:37], v18 offset:1184
    ds_read_b64_tr_b16 a[108:109], v21 offset:2048
    ds_read_b64_tr_b16 a[110:111], v21 offset:3072
    s_waitcnt lgkmcnt(0)
    s_add_u32 s96, s96, 9216
    s_add_u32 m0, s29, 2048
    s_nop 0
    buffer_load_dwordx4 v22, s[68:71], s96 offen offset:0  lds
    s_add_u32 s96, s96, 7168
    buffer_load_dwordx4 v22, s[68:71], s96 offen offset:1024  lds
    v_mfma_f32_32x32x16_bf16 a[240:255], v[52:55], v[60:63], a[240:255]
    ds_read_b64 v[38:39], v18 offset:1192
    v_mfma_f32_32x32x16_bf16 a[224:239], v[48:51], v[64:67], a[224:239]
    ds_read_b128 v[56:59], v19 offset:960
    ds_read_b64 v[40:41], v18 offset:1216
    s_waitcnt vmcnt(16)
    ds_read_b64_tr_b16 a[112:113], v20 offset:4096
    ds_read_b64_tr_b16 a[114:115], v20 offset:5120
    v_mfma_f32_32x32x16_bf16 a[240:255], v[32:35], v[64:67], a[240:255]
    ds_read_b64 v[42:43], v18 offset:1224
    ds_read_b64_tr_b16 a[116:117], v21 offset:4096
    ds_read_b64_tr_b16 a[118:119], v21 offset:5120
    s_waitcnt lgkmcnt(0)
    s_lshl_b32 s96, s85, 3
    s_add_u32 m0, s29, 4096
    s_nop 0
    buffer_load_dwordx4 v22, s[68:71], s96 offen offset:0  lds
    s_add_u32 s96, s96, 7168
    buffer_load_dwordx4 v22, s[68:71], s96 offen offset:1024  lds
    v_mfma_f32_32x32x16_bf16 a[224:239], v[52:55], v[68:71], a[224:239]
    ds_read_b128 v[60:63], v19 offset:928
    ds_read_b64 v[44:45], v18 offset:1248
    v_mfma_f32_32x32x16_bf16 a[240:255], v[36:39], v[68:71], a[240:255]
    ds_read_b64 v[46:47], v18 offset:1256
    s_waitcnt vmcnt(16)
    ds_read_b64_tr_b16 a[120:121], v20 offset:6144
    ds_read_b64_tr_b16 a[122:123], v20 offset:7168
    v_mfma_f32_32x32x16_bf16 a[224:239], v[32:35], v[56:59], a[224:239]
    ds_read_b128 v[64:67], v19 offset:896
    ds_read_b64 v[48:49], v18 offset:1280
    ds_read_b64_tr_b16 a[124:125], v21 offset:6144
    ds_read_b64_tr_b16 a[126:127], v21 offset:7168
    s_waitcnt lgkmcnt(0)
    s_add_u32 s96, s96, 9216
    s_add_u32 m0, s29, 6144
    s_nop 0
    buffer_load_dwordx4 v22, s[68:71], s96 offen offset:0  lds
    s_add_u32 s96, s96, 7168
    buffer_load_dwordx4 v22, s[68:71], s96 offen offset:1024  lds
    v_mfma_f32_32x32x16_bf16 a[240:255], v[40:43], v[56:59], a[240:255]
    ds_read_b64 v[50:51], v18 offset:1288
    v_mfma_f32_32x32x16_bf16 a[224:239], v[36:39], v[60:63], a[224:239]
    ds_read_b128 v[68:71], v19 offset:864
    ds_read_b64 v[52:53], v18 offset:1312
    s_waitcnt vmcnt(15)
    ds_read_b64_tr_b16 a[128:129], v20 offset:32768
    ds_read_b64_tr_b16 a[130:131], v20 offset:33792
    v_mfma_f32_32x32x16_bf16 a[240:255], v[44:47], v[60:63], a[240:255]
    ds_read_b64 v[54:55], v18 offset:1320
    ds_read_b64_tr_b16 a[132:133], v21 offset:32768
    ds_read_b64_tr_b16 a[134:135], v21 offset:33792
    s_waitcnt lgkmcnt(0)
    s_lshl_b32 s96, s86, 3
    s_add_u32 m0, s29, 32768
    s_nop 0
    buffer_load_dwordx4 v22, s[68:71], s96 offen offset:0  lds
    s_add_u32 s96, s96, 7168
    buffer_load_dwordx4 v22, s[68:71], s96 offen offset:1024  lds
    v_mfma_f32_32x32x16_bf16 a[224:239], v[40:43], v[64:67], a[224:239]
    ds_read_b128 v[56:59], v19 offset:816
    ds_read_b64 v[32:33], v18 offset:1344
    v_mfma_f32_32x32x16_bf16 a[240:255], v[48:51], v[64:67], a[240:255]
    ds_read_b64 v[34:35], v18 offset:1352
    s_waitcnt vmcnt(14)
    ds_read_b64_tr_b16 a[136:137], v20 offset:34816
    ds_read_b64_tr_b16 a[138:139], v20 offset:35840
    v_mfma_f32_32x32x16_bf16 a[224:239], v[44:47], v[68:71], a[224:239]
    ds_read_b128 v[60:63], v19 offset:784
    ds_read_b64 v[36:37], v18 offset:1376
    ds_read_b64_tr_b16 a[140:141], v21 offset:34816
    ds_read_b64_tr_b16 a[142:143], v21 offset:35840
    s_waitcnt lgkmcnt(0)
    s_add_u32 s96, s96, 9216
    s_add_u32 m0, s29, 34816
    s_nop 0
    buffer_load_dwordx4 v22, s[68:71], s96 offen offset:0  lds
    s_add_u32 s96, s96, 7168
    buffer_load_dwordx4 v22, s[68:71], s96 offen offset:1024  lds
    v_mfma_f32_32x32x16_bf16 a[240:255], v[52:55], v[68:71], a[240:255]
    ds_read_b64 v[38:39], v18 offset:1384
    v_mfma_f32_32x32x16_bf16 a[224:239], v[48:51], v[56:59], a[224:239]
    ds_read_b128 v[64:67], v19 offset:752
    ds_read_b64 v[40:41], v18 offset:1408
    s_waitcnt vmcnt(14)
    ds_read_b64_tr_b16 a[144:145], v20 offset:36864
    ds_read_b64_tr_b16 a[146:147], v20 offset:37888
    v_mfma_f32_32x32x16_bf16 a[240:255], v[32:35], v[56:59], a[240:255]
    ds_read_b64 v[42:43], v18 offset:1416
    ds_read_b64_tr_b16 a[148:149], v21 offset:36864
    ds_read_b64_tr_b16 a[150:151], v21 offset:37888
    s_waitcnt lgkmcnt(0)
    s_lshl_b32 s96, s87, 3
    s_add_u32 m0, s29, 36864
    s_nop 0
    buffer_load_dwordx4 v22, s[68:71], s96 offen offset:0  lds
    s_add_u32 s96, s96, 7168
    buffer_load_dwordx4 v22, s[68:71], s96 offen offset:1024  lds
    v_mfma_f32_32x32x16_bf16 a[224:239], v[52:55], v[60:63], a[224:239]
    ds_read_b128 v[68:71], v19 offset:720
    ds_read_b64 v[44:45], v18 offset:1440
    v_mfma_f32_32x32x16_bf16 a[240:255], v[36:39], v[60:63], a[240:255]
    ds_read_b64 v[46:47], v18 offset:1448
    s_waitcnt vmcnt(14)
    ds_read_b64_tr_b16 a[152:153], v20 offset:38912
    ds_read_b64_tr_b16 a[154:155], v20 offset:39936
    v_mfma_f32_32x32x16_bf16 a[224:239], v[32:35], v[64:67], a[224:239]
    ds_read_b128 v[56:59], v19 offset:672
    ds_read_b64 v[48:49], v18 offset:1472
    ds_read_b64_tr_b16 a[156:157], v21 offset:38912
    ds_read_b64_tr_b16 a[158:159], v21 offset:39936
    s_waitcnt lgkmcnt(0)
    s_add_u32 s96, s96, 9216
    s_add_u32 m0, s29, 38912
    s_nop 0
    buffer_load_dwordx4 v22, s[68:71], s96 offen offset:0  lds
    s_add_u32 s96, s96, 7168
    buffer_load_dwordx4 v22, s[68:71], s96 offen offset:1024  lds
    v_mfma_f32_32x32x16_bf16 a[240:255], v[40:43], v[64:67], a[240:255]
    ds_read_b64 v[50:51], v18 offset:1480
    s_mul_i32 s9, s97, 229376
    v_add_u32 v22, s9, v1
    s_mov_b64 s[68:69], s[38:39]
    s_mov_b32 s70, 2097152
    s_mov_b32 s71, 0x20000
    v_mfma_f32_32x32x16_bf16 a[224:239], v[36:39], v[68:71], a[224:239]
    ds_read_b128 v[60:63], v19 offset:640
    ds_read_b64 v[52:53], v18 offset:1504
    s_waitcnt vmcnt(14)
    ds_read_b64_tr_b16 a[160:161], v20 offset:0
    ds_read_b64_tr_b16 a[162:163], v20 offset:1024
    v_mfma_f32_32x32x16_bf16 a[240:255], v[44:47], v[68:71], a[240:255]
    ds_read_b64 v[54:55], v18 offset:1512
    ds_read_b64_tr_b16 a[164:165], v21 offset:0
    ds_read_b64_tr_b16 a[166:167], v21 offset:1024
    v_mfma_f32_32x32x16_bf16 a[224:239], v[40:43], v[56:59], a[224:239]
    ds_read_b128 v[64:67], v19 offset:608
    ds_read_b64 v[32:33], v18 offset:1536
    s_waitcnt lgkmcnt(9)
    v_mfma_f32_32x32x16_bf16 a[240:255], v[48:51], v[56:59], a[240:255]
    ds_read_b64 v[34:35], v18 offset:1544
    s_waitcnt vmcnt(12)
    ds_read_b64_tr_b16 a[168:169], v20 offset:2048
    ds_read_b64_tr_b16 a[170:171], v20 offset:3072
    s_waitcnt lgkmcnt(11)
    v_mfma_f32_32x32x16_bf16 a[224:239], v[44:47], v[60:63], a[224:239]
    ds_read_b128 v[68:71], v19 offset:576
    ds_read_b64 v[36:37], v18 offset:1568
    ds_read_b64_tr_b16 a[172:173], v21 offset:2048
    ds_read_b64_tr_b16 a[174:175], v21 offset:3072
    s_waitcnt lgkmcnt(11)
    v_mfma_f32_32x32x16_bf16 a[240:255], v[52:55], v[60:63], a[240:255]
    ds_read_b64 v[38:39], v18 offset:1576
    s_waitcnt lgkmcnt(9)
    v_mfma_f32_32x32x16_bf16 a[224:239], v[48:51], v[64:67], a[224:239]
    ds_read_b128 v[56:59], v19 offset:528
    ds_read_b64 v[40:41], v18 offset:1600
    s_waitcnt vmcnt(10)
    ds_read_b64_tr_b16 a[176:177], v20 offset:4096
    ds_read_b64_tr_b16 a[178:179], v20 offset:5120
    s_waitcnt lgkmcnt(11)
    v_mfma_f32_32x32x16_bf16 a[240:255], v[32:35], v[64:67], a[240:255]
    ds_read_b64 v[42:43], v18 offset:1608
    ds_read_b64_tr_b16 a[180:181], v21 offset:4096
    ds_read_b64_tr_b16 a[182:183], v21 offset:5120
    s_waitcnt lgkmcnt(11)
    v_mfma_f32_32x32x16_bf16 a[224:239], v[52:55], v[68:71], a[224:239]
    ds_read_b128 v[60:63], v19 offset:496
    ds_read_b64 v[44:45], v18 offset:1632
    s_waitcnt lgkmcnt(9)
    v_mfma_f32_32x32x16_bf16 a[240:255], v[36:39], v[68:71], a[240:255]
    ds_read_b64 v[46:47], v18 offset:1640
    s_waitcnt vmcnt(8)
    ds_read_b64_tr_b16 a[184:185], v20 offset:6144
    ds_read_b64_tr_b16 a[186:187], v20 offset:7168
    s_waitcnt lgkmcnt(11)
    v_mfma_f32_32x32x16_bf16 a[224:239], v[32:35], v[56:59], a[224:239]
    ds_read_b128 v[64:67], v19 offset:464
    ds_read_b64 v[48:49], v18 offset:1664
    ds_read_b64_tr_b16 a[188:189], v21 offset:6144
    ds_read_b64_tr_b16 a[190:191], v21 offset:7168
    s_waitcnt lgkmcnt(11)
    v_mfma_f32_32x32x16_bf16 a[240:255], v[40:43], v[56:59], a[240:255]
    ds_read_b64 v[50:51], v18 offset:1672
    s_waitcnt lgkmcnt(9)
    v_mfma_f32_32x32x16_bf16 a[224:239], v[36:39], v[60:63], a[224:239]
    ds_read_b128 v[68:71], v19 offset:432
    ds_read_b64 v[52:53], v18 offset:1696
    s_waitcnt vmcnt(6)
    ds_read_b64_tr_b16 a[192:193], v20 offset:32768
    ds_read_b64_tr_b16 a[194:195], v20 offset:33792
    s_waitcnt lgkmcnt(11)
    v_mfma_f32_32x32x16_bf16 a[240:255], v[44:47], v[60:63], a[240:255]
    ds_read_b64 v[54:55], v18 offset:1704
    ds_read_b64_tr_b16 a[196:197], v21 offset:32768
    ds_read_b64_tr_b16 a[198:199], v21 offset:33792
    s_waitcnt lgkmcnt(11)
    v_mfma_f32_32x32x16_bf16 a[224:239], v[40:43], v[64:67], a[224:239]
    ds_read_b128 v[56:59], v19 offset:384
    ds_read_b64 v[32:33], v18 offset:1728
    v_min_u32 v23, 6, v0
    v_lshlrev_b32 v23, 7, v23
    s_mul_i32 s14, s97, 3584
    s_mul_i32 s15, s88, 896
    s_add_u32 s14, s14, s15
    s_add_u32 s14, s14, 13893632
    s_waitcnt lgkmcnt(9)
    v_mfma_f32_32x32x16_bf16 a[240:255], v[48:51], v[64:67], a[240:255]
    ds_read_b64 v[34:35], v18 offset:1736
    s_waitcnt vmcnt(4)
    ds_read_b64_tr_b16 a[200:201], v20 offset:34816
    ds_read_b64_tr_b16 a[202:203], v20 offset:35840
    buffer_load_dwordx2 v[24:25], v23, s[56:59], s14 offen sc1
    s_waitcnt lgkmcnt(11)
    v_mfma_f32_32x32x16_bf16 a[224:239], v[44:47], v[68:71], a[224:239]
    ds_read_b128 v[60:63], v19 offset:352
    ds_read_b64 v[36:37], v18 offset:1760
    ds_read_b64_tr_b16 a[204:205], v21 offset:34816
    ds_read_b64_tr_b16 a[206:207], v21 offset:35840
    s_waitcnt lgkmcnt(11)
    v_mfma_f32_32x32x16_bf16 a[240:255], v[52:55], v[68:71], a[240:255]
    ds_read_b64 v[38:39], v18 offset:1768
    s_waitcnt lgkmcnt(9)
    v_mfma_f32_32x32x16_bf16 a[224:239], v[48:51], v[56:59], a[224:239]
    ds_read_b128 v[64:67], v19 offset:320
    ds_read_b64 v[40:41], v18 offset:1792
    s_waitcnt vmcnt(3)
    ds_read_b64_tr_b16 a[208:209], v20 offset:36864
    ds_read_b64_tr_b16 a[210:211], v20 offset:37888
    s_waitcnt lgkmcnt(11)
    v_mfma_f32_32x32x16_bf16 a[240:255], v[32:35], v[56:59], a[240:255]
    ds_read_b64 v[42:43], v18 offset:1800
    ds_read_b64_tr_b16 a[212:213], v21 offset:36864
    ds_read_b64_tr_b16 a[214:215], v21 offset:37888
    s_waitcnt lgkmcnt(11)
    v_mfma_f32_32x32x16_bf16 a[224:239], v[52:55], v[60:63], a[224:239]
    ds_read_b128 v[68:71], v19 offset:288
    ds_read_b64 v[44:45], v18 offset:1824
    s_waitcnt lgkmcnt(9)
    v_mfma_f32_32x32x16_bf16 a[240:255], v[36:39], v[60:63], a[240:255]
    ds_read_b64 v[46:47], v18 offset:1832
    s_waitcnt vmcnt(1)
    ds_read_b64_tr_b16 a[216:217], v20 offset:38912
    ds_read_b64_tr_b16 a[218:219], v20 offset:39936
    s_waitcnt lgkmcnt(11)
    v_mfma_f32_32x32x16_bf16 a[224:239], v[32:35], v[64:67], a[224:239]
    ds_read_b128 v[56:59], v19 offset:240
    ds_read_b64 v[48:49], v18 offset:1856
    ds_read_b64_tr_b16 a[220:221], v21 offset:38912
    ds_read_b64_tr_b16 a[222:223], v21 offset:39936
    s_waitcnt lgkmcnt(11)
    v_mfma_f32_32x32x16_bf16 a[240:255], v[40:43], v[64:67], a[240:255]
    ds_read_b64 v[50:51], v18 offset:1864
    s_waitcnt lgkmcnt(9)
    v_mfma_f32_32x32x16_bf16 a[224:239], v[36:39], v[68:71], a[224:239]
    ds_read_b128 v[60:63], v19 offset:208
    ds_read_b64 v[52:53], v18 offset:1888
    s_waitcnt lgkmcnt(9)
    v_mfma_f32_32x32x16_bf16 a[240:255], v[44:47], v[68:71], a[240:255]
    ds_read_b64 v[54:55], v18 offset:1896
    s_waitcnt lgkmcnt(7)
    v_mfma_f32_32x32x16_bf16 a[224:239], v[40:43], v[56:59], a[224:239]
    ds_read_b128 v[64:67], v19 offset:176
    ds_read_b64 v[32:33], v18 offset:1920
    s_waitcnt lgkmcnt(5)
    v_mfma_f32_32x32x16_bf16 a[240:255], v[48:51], v[56:59], a[240:255]
    ds_read_b64 v[34:35], v18 offset:1928
    s_waitcnt lgkmcnt(5)
    v_mfma_f32_32x32x16_bf16 a[224:239], v[44:47], v[60:63], a[224:239]
    ds_read_b128 v[68:71], v19 offset:144
    ds_read_b64 v[36:37], v18 offset:1952
    s_waitcnt lgkmcnt(5)
    v_mfma_f32_32x32x16_bf16 a[240:255], v[52:55], v[60:63], a[240:255]
    ds_read_b64 v[38:39], v18 offset:1960
    s_waitcnt lgkmcnt(5)
    v_mfma_f32_32x32x16_bf16 a[224:239], v[48:51], v[64:67], a[224:239]
    ds_read_b128 v[56:59], v19 offset:96
    ds_read_b64 v[40:41], v18 offset:1984
    s_waitcnt vmcnt(0)
    v_cmp_eq_u64 vcc, s[72:73], v[24:25]
    s_nop 0
    s_cmp_eq_u64 vcc, exec
    s_cbranch_scc1 L_ok_7
    s_mov_b32 s100, 0
    L_lp_8:
    buffer_load_dwordx2 v[24:25], v23, s[56:59], s14 offen sc1
    s_waitcnt vmcnt(0)
    v_cmp_eq_u64 vcc, s[72:73], v[24:25]
    s_add_u32 s100, s100, 1
    s_nop 1
    s_cmp_eq_u64 vcc, exec
    s_cbranch_scc1 L_ok_7
    s_sleep 4
    s_cmp_lt_u32 s100, 200000
    s_cbranch_scc1 L_lp_8
L_ok_7:
    s_waitcnt lgkmcnt(5)
    v_mfma_f32_32x32x16_bf16 a[240:255], v[32:35], v[64:67], a[240:255]
    ds_read_b64 v[42:43], v18 offset:1992
    buffer_load_dwordx4 v[160:163], v22, s[56:59], s74 offen offset:0 sc1
    s_waitcnt lgkmcnt(5)
    v_mfma_f32_32x32x16_bf16 a[224:239], v[52:55], v[68:71], a[224:239]
    ds_read_b128 v[60:63], v19 offset:64
    ds_read_b64 v[44:45], v18 offset:2016
    buffer_load_dwordx4 v[164:167], v22, s[56:59], s74 offen offset:2048 sc1
    s_waitcnt lgkmcnt(5)
    v_mfma_f32_32x32x16_bf16 a[240:255], v[36:39], v[68:71], a[240:255]
    ds_read_b64 v[46:47], v18 offset:2024
    buffer_load_dwordx4 v[168:171], v22, s[56:59], s75 offen offset:0 sc1
    s_waitcnt lgkmcnt(5)
    v_mfma_f32_32x32x16_bf16 a[224:239], v[32:35], v[56:59], a[224:239]
    ds_read_b128 v[64:67], v19 offset:32
    ds_read_b64 v[48:49], v18 offset:2048
    buffer_load_dwordx4 v[172:175], v22, s[56:59], s75 offen offset:2048 sc1
    s_waitcnt lgkmcnt(5)
    v_mfma_f32_32x32x16_bf16 a[240:255], v[40:43], v[56:59], a[240:255]
    ds_read_b64 v[50:51], v18 offset:2056
    buffer_load_dwordx4 v[176:179], v22, s[56:59], s76 offen offset:0 sc1
    s_waitcnt lgkmcnt(5)
    v_mfma_f32_32x32x16_bf16 a[224:239], v[36:39], v[60:63], a[224:239]
    ds_read_b128 v[68:71], v19 offset:0
    ds_read_b64 v[52:53], v18 offset:2080
    buffer_load_dwordx4 v[180:183], v22, s[56:59], s76 offen offset:2048 sc1
    s_waitcnt lgkmcnt(5)
    v_mfma_f32_32x32x16_bf16 a[240:255], v[44:47], v[60:63], a[240:255]
    ds_read_b64 v[54:55], v18 offset:2088
    buffer_load_dwordx4 v[184:187], v22, s[56:59], s77 offen offset:0 sc1
    s_waitcnt lgkmcnt(5)
    v_mfma_f32_32x32x16_bf16 a[224:239], v[40:43], v[64:67], a[224:239]
    buffer_load_dwordx4 v[188:191], v22, s[56:59], s77 offen offset:2048 sc1
    s_waitcnt lgkmcnt(3)
    v_mfma_f32_32x32x16_bf16 a[240:255], v[48:51], v[64:67], a[240:255]
    buffer_load_dwordx4 v[192:195], v22, s[56:59], s78 offen offset:0 sc1
    s_waitcnt lgkmcnt(2)
    v_mfma_f32_32x32x16_bf16 a[224:239], v[44:47], v[68:71], a[224:239]
    buffer_load_dwordx4 v[196:199], v22, s[56:59], s78 offen offset:2048 sc1
    s_waitcnt lgkmcnt(0)
    v_mfma_f32_32x32x16_bf16 a[240:255], v[52:55], v[68:71], a[240:255]
    buffer_load_dwordx4 v[200:203], v22, s[56:59], s79 offen offset:0 sc1
    s_waitcnt vmcnt(10)
    v_mfma_f32_32x32x16_bf16 v[32:47], a[0:3], v[160:163], 0
    buffer_load_dwordx4 v[204:207], v22, s[56:59], s79 offen offset:2048 sc1
    v_mfma_f32_32x32x16_bf16 v[48:63], a[4:7], v[160:163], 0
    s_nop 3
    ds_write_b128 v30, a[224:227] offset:0
    ds_write_b128 v30, a[228:231] offset:32
    ds_write_b128 v30, a[232:235] offset:64
    ds_write_b128 v30, a[236:239] offset:96
    s_waitcnt vmcnt(10)
    v_mfma_f32_32x32x16_bf16 v[32:47], a[8:11], v[164:167], v[32:47]
    buffer_load_dwordx4 v[208:211], v22, s[56:59], s80 offen offset:0 sc1
    ds_write_b128 v30, a[240:243] offset:128
    ds_write_b128 v30, a[244:247] offset:160
    ds_write_b128 v30, a[248:251] offset:192
    v_mfma_f32_32x32x16_bf16 v[48:63], a[12:15], v[164:167], v[48:63]
    ds_write_b128 v30, a[252:255] offset:224
    s_waitcnt vmcnt(10)
    v_mfma_f32_32x32x16_bf16 v[32:47], a[16:19], v[168:171], v[32:47]
    buffer_load_dwordx4 v[212:215], v22, s[56:59], s80 offen offset:2048 sc1
    v_mfma_f32_32x32x16_bf16 v[48:63], a[20:23], v[168:171], v[48:63]
    s_waitcnt lgkmcnt(0)
    s_barrier
    ds_read_b128 v[96:99], v152 offset:0
    ds_read_b128 v[100:103], v152 offset:16
    ds_read_b128 v[104:107], v152 offset:16384
    s_waitcnt vmcnt(10)
    v_mfma_f32_32x32x16_bf16 v[32:47], a[24:27], v[172:175], v[32:47]
    buffer_load_dwordx4 v[216:219], v22, s[56:59], s81 offen offset:0 sc1
    ds_read_b128 v[108:111], v152 offset:16400
    ds_read_b128 v[112:115], v153 offset:0
    s_waitcnt lgkmcnt(2)
    v_add_f32 v96, v96, v104
    v_add_f32 v97, v97, v105
    v_mfma_f32_32x32x16_bf16 v[48:63], a[28:31], v[172:175], v[48:63]
    v_add_f32 v98, v98, v106
    v_add_f32 v99, v99, v107
    s_waitcnt lgkmcnt(1)
    v_add_f32 v100, v100, v108
    v_add_f32 v101, v101, v109
    v_add_f32 v102, v102, v110
    s_waitcnt vmcnt(10)
    v_mfma_f32_32x32x16_bf16 v[32:47], a[32:35], v[176:179], v[32:47]
    buffer_load_dwordx4 v[220:223], v22, s[56:59], s81 offen offset:2048 sc1
    v_add_f32 v103, v103, v111
    s_waitcnt lgkmcnt(0)
    v_lshlrev_b32 v116, 16, v112
    v_and_b32 v117, s99, v112
    v_fmac_f32 v103, s101, v116
    v_mfma_f32_32x32x16_bf16 v[48:63], a[36:39], v[176:179], v[48:63]
    v_fmac_f32 v102, s101, v117
    v_lshlrev_b32 v116, 16, v113
    v_and_b32 v117, s99, v113
    v_fmac_f32 v101, s101, v116
    v_fmac_f32 v100, s101, v117
    s_waitcnt vmcnt(10)
    v_mfma_f32_32x32x16_bf16 v[32:47], a[40:43], v[180:183], v[32:47]
    buffer_load_dwordx4 v[224:227], v22, s[56:59], s82 offen offset:0 sc1
    v_lshlrev_b32 v116, 16, v114
    v_and_b32 v117, s99, v114
    v_fmac_f32 v99, s101, v116
    v_fmac_f32 v98, s101, v117
    v_mfma_f32_32x32x16_bf16 v[48:63], a[44:47], v[180:183], v[48:63]
    v_lshlrev_b32 v116, 16, v115
    v_and_b32 v117, s99, v115
    v_fmac_f32 v97, s101, v116
    v_fmac_f32 v96, s101, v117
    v_cvt_pk_bf16_f32 v120, v96, v97
    s_waitcnt vmcnt(10)
    v_mfma_f32_32x32x16_bf16 v[32:47], a[48:51], v[184:187], v[32:47]
    buffer_load_dwordx4 v[228:231], v22, s[56:59], s82 offen offset:2048 sc1
    v_cvt_pk_bf16_f32 v121, v98, v99
    v_cvt_pk_bf16_f32 v122, v100, v101
    v_cvt_pk_bf16_f32 v123, v102, v103
    v_mfma_f32_32x32x16_bf16 v[48:63], a[52:55], v[184:187], v[48:63]
    buffer_store_dwordx4 v[120:123], v1, s[56:59], s12 offen offset:0 sc1
    ds_read_b128 v[96:99], v152 offset:2176
    ds_read_b128 v[100:103], v152 offset:2192
    ds_read_b128 v[104:107], v152 offset:18560
    s_waitcnt vmcnt(11)
    v_mfma_f32_32x32x16_bf16 v[32:47], a[56:59], v[188:191], v[32:47]
    buffer_load_dwordx4 v[232:235], v22, s[56:59], s83 offen offset:0 sc1
    ds_read_b128 v[108:111], v152 offset:18576
    ds_read_b128 v[112:115], v153 offset:1152
    s_waitcnt lgkmcnt(2)
    v_add_f32 v96, v96, v104
    v_add_f32 v97, v97, v105
    v_mfma_f32_32x32x16_bf16 v[48:63], a[60:63], v[188:191], v[48:63]
    v_add_f32 v98, v98, v106
    v_add_f32 v99, v99, v107
    s_waitcnt lgkmcnt(1)
    v_add_f32 v100, v100, v108
    v_add_f32 v101, v101, v109
    v_add_f32 v102, v102, v110
    s_waitcnt vmcnt(11)
    v_mfma_f32_32x32x16_bf16 v[32:47], a[64:67], v[192:195], v[32:47]
    buffer_load_dwordx4 v[236:239], v22, s[56:59], s83 offen offset:2048 sc1
    v_add_f32 v103, v103, v111
    s_waitcnt lgkmcnt(0)
    v_lshlrev_b32 v116, 16, v112
    v_and_b32 v117, s99, v112
    v_fmac_f32 v103, s101, v116
    v_mfma_f32_32x32x16_bf16 v[48:63], a[68:71], v[192:195], v[48:63]
    v_fmac_f32 v102, s101, v117
    v_lshlrev_b32 v116, 16, v113
    v_and_b32 v117, s99, v113
    v_fmac_f32 v101, s101, v116
    v_fmac_f32 v100, s101, v117
    s_waitcnt vmcnt(11)
    v_mfma_f32_32x32x16_bf16 v[32:47], a[72:75], v[196:199], v[32:47]
    buffer_load_dwordx4 v[240:243], v22, s[56:59], s84 offen offset:0 sc1
    v_lshlrev_b32 v116, 16, v114
    v_and_b32 v117, s99, v114
    v_fmac_f32 v99, s101, v116
    v_fmac_f32 v98, s101, v117
    v_mfma_f32_32x32x16_bf16 v[48:63], a[76:79], v[196:199], v[48:63]
    v_lshlrev_b32 v116, 16, v115
    v_and_b32 v117, s99, v115
    v_fmac_f32 v97, s101, v116
    v_fmac_f32 v96, s101, v117
    v_cvt_pk_bf16_f32 v124, v96, v97
    s_waitcnt vmcnt(11)
    v_mfma_f32_32x32x16_bf16 v[32:47], a[80:83], v[200:203], v[32:47]
    buffer_load_dwordx4 v[244:247], v22, s[56:59], s84 offen offset:2048 sc1
    v_cvt_pk_bf16_f32 v125, v98, v99
    v_cvt_pk_bf16_f32 v126, v100, v101
    v_cvt_pk_bf16_f32 v127, v102, v103
    v_mfma_f32_32x32x16_bf16 v[48:63], a[84:87], v[200:203], v[48:63]
    buffer_store_dwordx4 v[124:127], v1, s[56:59], s12 offen offset:1024 sc1
    v_lshrrev_b32 v28, 3, v0
    v_lshlrev_b32 v28, 10, v28
    v_and_b32 v29, 7, v0
    v_lshrrev_b32 v30, 4, v0
    s_waitcnt vmcnt(12)
    v_mfma_f32_32x32x16_bf16 v[32:47], a[88:91], v[204:207], v[32:47]
    buffer_load_dwordx4 v[248:251], v22, s[56:59], s85 offen offset:0 sc1
    v_xor_b32 v29, v29, v30
    v_lshl_add_u32 v12, v29, 4, v28
    v_xor_b32 v13, 64, v12
    v_add_u32 v13, 7168, v13
    v_mfma_f32_32x32x16_bf16 v[48:63], a[92:95], v[204:207], v[48:63]
    s_lshl_b32 s5, s97, 16
    s_lshl_b32 s6, s88, 14
    s_add_u32 s5, s5, s6
    s_lshl_b32 s6, s98, 7
    s_add_u32 s5, s5, s6
    s_waitcnt vmcnt(12)
    v_mfma_f32_32x32x16_bf16 v[32:47], a[96:99], v[208:211], v[32:47]
    buffer_load_dwordx4 v[252:255], v22, s[56:59], s85 offen offset:2048 sc1
    s_lshl_b32 s6, s88, 11
    s_add_u32 m0, s6, 147456
    s_nop 0
    buffer_load_dwordx4 v12, s[44:47], s5 offen offset:0 lds
    buffer_load_dwordx4 v13, s[44:47], s5 offen offset:1024 lds
    v_mfma_f32_32x32x16_bf16 v[48:63], a[100:103], v[208:211], v[48:63]
    v_and_b32 v23, 31, v0
    v_lshlrev_b32 v23, 3, v23
    s_lshl_b32 s14, s97, 9
    s_add_u32 s14, s14, 13631488
    buffer_load_dwordx2 v[116:117], v23, s[56:59], s14 offen offset:0 sc1
    s_waitcnt vmcnt(15)
    v_mfma_f32_32x32x16_bf16 v[32:47], a[104:107], v[212:215], v[32:47]
    buffer_load_dwordx4 v[160:163], v22, s[56:59], s86 offen offset:0 sc1
    buffer_load_dwordx2 v[118:119], v23, s[56:59], s14 offen offset:256 sc1
    v_mfma_f32_32x32x16_bf16 v[48:63], a[108:111], v[212:215], v[48:63]
    s_waitcnt vmcnt(16)
    v_mfma_f32_32x32x16_bf16 v[32:47], a[112:115], v[216:219], v[32:47]
    buffer_load_dwordx4 v[164:167], v22, s[56:59], s86 offen offset:2048 sc1
    v_mfma_f32_32x32x16_bf16 v[48:63], a[116:119], v[216:219], v[48:63]
    s_waitcnt vmcnt(16)
    v_mfma_f32_32x32x16_bf16 v[32:47], a[120:123], v[220:223], v[32:47]
    buffer_load_dwordx4 v[168:171], v22, s[56:59], s87 offen offset:0 sc1
    v_mfma_f32_32x32x16_bf16 v[48:63], a[124:127], v[220:223], v[48:63]
    s_waitcnt vmcnt(16)
    v_mfma_f32_32x32x16_bf16 v[32:47], a[128:131], v[224:227], v[32:47]
    buffer_load_dwordx4 v[172:175], v22, s[56:59], s87 offen offset:2048 sc1
    v_mfma_f32_32x32x16_bf16 v[48:63], a[132:135], v[224:227], v[48:63]
    s_waitcnt vmcnt(16)
    v_mfma_f32_32x32x16_bf16 v[32:47], a[136:139], v[228:231], v[32:47]
    buffer_load_dwordx4 v[176:179], v22, s[56:59], s74 offen offset:1024 sc1
    v_mfma_f32_32x32x16_bf16 v[48:63], a[140:143], v[228:231], v[48:63]
    s_waitcnt vmcnt(15)
    v_mfma_f32_32x32x16_bf16 v[32:47], a[144:147], v[232:235], v[32:47]
    buffer_load_dwordx4 v[180:183], v22, s[56:59], s74 offen offset:3072 sc1
    v_mfma_f32_32x32x16_bf16 v[48:63], a[148:151], v[232:235], v[48:63]
    s_waitcnt vmcnt(15)
    v_mfma_f32_32x32x16_bf16 v[32:47], a[152:155], v[236:239], v[32:47]
    buffer_load_dwordx4 v[184:187], v22, s[56:59], s75 offen offset:1024 sc1
    v_mfma_f32_32x32x16_bf16 v[48:63], a[156:159], v[236:239], v[48:63]
    s_waitcnt vmcnt(15)
    v_mfma_f32_32x32x16_bf16 v[32:47], a[160:163], v[240:243], v[32:47]
    buffer_load_dwordx4 v[188:191], v22, s[56:59], s75 offen offset:3072 sc1
    v_mfma_f32_32x32x16_bf16 v[48:63], a[164:167], v[240:243], v[48:63]
    s_waitcnt vmcnt(15)
    v_mfma_f32_32x32x16_bf16 v[32:47], a[168:171], v[244:247], v[32:47]
    buffer_load_dwordx4 v[192:195], v22, s[56:59], s76 offen offset:1024 sc1
    v_mov_b32 v28, 0
    s_waitcnt vmcnt(15)
    s_mov_b64 exec, 1
    buffer_store_dwordx2 v[26:27], v28, s[56:59], s11 offen sc1
    s_mov_b64 exec, -1
    v_mfma_f32_32x32x16_bf16 v[48:63], a[172:175], v[244:247], v[48:63]
    s_waitcnt vmcnt(11)
    v_cmp_eq_u32 vcc, s72, v117
    s_waitcnt vmcnt(9)
    v_cmp_eq_u32 s[6:7], s72, v119
    s_nop 0
    s_and_b64 vcc, vcc, s[6:7]
    s_cmp_eq_u64 vcc, exec
    s_cbranch_scc1 L_gok_9
    s_mov_b32 s100, 0
    L_glp_10:
    buffer_load_dwordx2 v[116:117], v23, s[56:59], s14 offen offset:0 sc1
    buffer_load_dwordx2 v[118:119], v23, s[56:59], s14 offen offset:256 sc1
    s_waitcnt vmcnt(0)
    v_cmp_eq_u32 vcc, s72, v117
    v_cmp_eq_u32 s[6:7], s72, v119
    s_add_u32 s100, s100, 1
    s_nop 1
    s_and_b64 vcc, vcc, s[6:7]
    s_cmp_eq_u64 vcc, exec
    s_cbranch_scc1 L_gok_9
    s_sleep 4
    s_cmp_lt_u32 s100, 200000
    s_cbranch_scc1 L_glp_10
L_gok_9:
    v_mfma_f32_32x32x16_bf16 v[32:47], a[176:179], v[248:251], v[32:47]
    buffer_load_dwordx4 v[196:199], v22, s[56:59], s76 offen offset:3072 sc1
    v_mov_b32 v152, v116
    v_mov_b32 v153, v118
    v_mfma_f32_32x32x16_bf16 v[48:63], a[180:183], v[248:251], v[48:63]
    v_mfma_f32_32x32x16_bf16 v[32:47], a[184:187], v[252:255], v[32:47]
    buffer_load_dwordx4 v[200:203], v22, s[56:59], s77 offen offset:1024 sc1
    v_mfma_f32_32x32x16_bf16 v[48:63], a[188:191], v[252:255], v[48:63]
    v_mfma_f32_32x32x16_bf16 v[32:47], a[192:195], v[160:163], v[32:47]
    buffer_load_dwordx4 v[204:207], v22, s[56:59], s77 offen offset:3072 sc1
    v_mfma_f32_32x32x16_bf16 v[48:63], a[196:199], v[160:163], v[48:63]
    s_waitcnt vmcnt(11)
    v_mfma_f32_32x32x16_bf16 v[32:47], a[200:203], v[164:167], v[32:47]
    buffer_load_dwordx4 v[208:211], v22, s[56:59], s78 offen offset:1024 sc1
    v_mfma_f32_32x32x16_bf16 v[48:63], a[204:207], v[164:167], v[48:63]
    s_waitcnt vmcnt(11)
    v_mfma_f32_32x32x16_bf16 v[32:47], a[208:211], v[168:171], v[32:47]
    buffer_load_dwordx4 v[212:215], v22, s[56:59], s78 offen offset:3072 sc1
    v_mfma_f32_32x32x16_bf16 v[48:63], a[212:215], v[168:171], v[48:63]
    s_waitcnt vmcnt(11)
    v_mfma_f32_32x32x16_bf16 v[32:47], a[216:219], v[172:175], v[32:47]
    buffer_load_dwordx4 v[216:219], v22, s[56:59], s79 offen offset:1024 sc1
    v_mfma_f32_32x32x16_bf16 v[48:63], a[220:223], v[172:175], v[48:63]
    s_waitcnt vmcnt(11)
    v_mfma_f32_32x32x16_bf16 v[64:79], a[0:3], v[176:179], 0
    buffer_load_dwordx4 v[220:223], v22, s[56:59], s79 offen offset:3072 sc1
    v_mfma_f32_32x32x16_bf16 v[80:95], a[4:7], v[176:179], 0
    s_waitcnt vmcnt(11)
    v_mfma_f32_32x32x16_bf16 v[64:79], a[8:11], v[180:183], v[64:79]
    buffer_load_dwordx4 v[224:227], v22, s[56:59], s80 offen offset:1024 sc1
    v_mfma_f32_32x32x16_bf16 v[80:95], a[12:15], v[180:183], v[80:95]
    s_waitcnt vmcnt(11)
    v_mfma_f32_32x32x16_bf16 v[64:79], a[16:19], v[184:187], v[64:79]
    buffer_load_dwordx4 v[228:231], v22, s[56:59], s80 offen offset:3072 sc1
    v_mfma_f32_32x32x16_bf16 v[80:95], a[20:23], v[184:187], v[80:95]
    s_waitcnt vmcnt(11)
    v_mfma_f32_32x32x16_bf16 v[64:79], a[24:27], v[188:191], v[64:79]
    buffer_load_dwordx4 v[232:235], v22, s[56:59], s81 offen offset:1024 sc1
    v_mfma_f32_32x32x16_bf16 v[80:95], a[28:31], v[188:191], v[80:95]
    s_waitcnt vmcnt(11)
    v_mfma_f32_32x32x16_bf16 v[64:79], a[32:35], v[192:195], v[64:79]
    buffer_load_dwordx4 v[236:239], v22, s[56:59], s81 offen offset:3072 sc1
    v_mfma_f32_32x32x16_bf16 v[80:95], a[36:39], v[192:195], v[80:95]
    s_waitcnt vmcnt(10)
    v_mfma_f32_32x32x16_bf16 v[64:79], a[40:43], v[196:199], v[64:79]
    buffer_load_dwordx4 v[240:243], v22, s[56:59], s82 offen offset:1024 sc1
    v_mfma_f32_32x32x16_bf16 v[80:95], a[44:47], v[196:199], v[80:95]
    s_waitcnt vmcnt(10)
    v_mfma_f32_32x32x16_bf16 v[64:79], a[48:51], v[200:203], v[64:79]
    buffer_load_dwordx4 v[244:247], v22, s[56:59], s82 offen offset:3072 sc1
    s_and_b32 s10, s88, 1
    s_lshl_b32 s10, s10, 1
    s_lshr_b32 s15, s88, 1
    s_add_u32 s10, s10, s15
    v_mfma_f32_32x32x16_bf16 v[80:95], a[52:55], v[200:203], v[80:95]
    v_and_b32 v23, 15, v0
    v_lshlrev_b32 v23, 7, v23
    s_lshl_b32 s14, s98, 1
    s_lshr_b32 s15, s97, 4
    s_add_u32 s14, s14, s15
    s_waitcnt vmcnt(10)
    v_mfma_f32_32x32x16_bf16 v[64:79], a[56:59], v[204:207], v[64:79]
    buffer_load_dwordx4 v[248:251], v22, s[56:59], s83 offen offset:1024 sc1
    s_lshl_b32 s14, s14, 13
    s_lshl_b32 s15, s10, 11
    s_add_u32 s14, s14, s15
    s_add_u32 s14, s14, 14155776
    v_mfma_f32_32x32x16_bf16 v[80:95], a[60:63], v[204:207], v[80:95]
    buffer_load_dwordx2 v[24:25], v23, s[56:59], s14 offen sc1
    ds_write_b128 v154, v[40:43] offset:0
    ds_write_b128 v154, v[44:47] offset:1024
    ds_write_b128 v155, v[48:51] offset:2048
    s_waitcnt vmcnt(11)
    v_mfma_f32_32x32x16_bf16 v[64:79], a[64:67], v[208:211], v[64:79]
    buffer_load_dwordx4 v[252:255], v22, s[56:59], s83 offen offset:3072 sc1
    ds_write_b128 v155, v[52:55] offset:3072
    ds_write_b128 v156, v[56:59] offset:4096
    ds_write_b128 v156, v[60:63] offset:5120
    v_mfma_f32_32x32x16_bf16 v[80:95], a[68:71], v[208:211], v[80:95]
    s_waitcnt vmcnt(11)
    v_mfma_f32_32x32x16_bf16 v[64:79], a[72:75], v[212:215], v[64:79]
    buffer_load_dwordx4 v[160:163], v22, s[56:59], s84 offen offset:1024 sc1
    v_mfma_f32_32x32x16_bf16 v[80:95], a[76:79], v[212:215], v[80:95]
    s_waitcnt lgkmcnt(0)
    s_barrier
    ds_read_b128 v[96:99], v157 offset:0
    ds_read_b128 v[100:103], v157 offset:1024
    ds_read_b128 v[104:107], v157 offset:2048
    s_waitcnt vmcnt(11)
    v_mfma_f32_32x32x16_bf16 v[64:79], a[80:83], v[216:219], v[64:79]
    buffer_load_dwordx4 v[164:167], v22, s[56:59], s84 offen offset:3072 sc1
    ds_read_b128 v[108:111], v157 offset:3072
    ds_read_b128 v[112:115], v157 offset:4096
    ds_read_b128 v[116:119], v157 offset:5120
    v_mfma_f32_32x32x16_bf16 v[80:95], a[84:87], v[216:219], v[80:95]
    s_waitcnt vmcnt(11)
    v_mfma_f32_32x32x16_bf16 v[64:79], a[88:91], v[220:223], v[64:79]
    buffer_load_dwordx4 v[168:171], v22, s[56:59], s85 offen offset:1024 sc1
    s_waitcnt lgkmcnt(3)
    v_add_f32 v96, v96, v104
    v_add_f32 v97, v97, v105
    v_add_f32 v98, v98, v106
    v_add_f32 v99, v99, v107
    v_mfma_f32_32x32x16_bf16 v[80:95], a[92:95], v[220:223], v[80:95]
    s_waitcnt lgkmcnt(2)
    v_add_f32 v100, v100, v108
    v_add_f32 v101, v101, v109
    v_add_f32 v102, v102, v110
    v_add_f32 v103, v103, v111
    s_waitcnt lgkmcnt(1)
    v_add_f32 v128, v32, v112
    s_waitcnt vmcnt(11)
    v_mfma_f32_32x32x16_bf16 v[64:79], a[96:99], v[224:227], v[64:79]
    buffer_load_dwordx4 v[172:175], v22, s[56:59], s85 offen offset:3072 sc1
    v_add_f32 v129, v33, v113
    v_add_f32 v130, v34, v114
    v_add_f32 v131, v35, v115
    s_waitcnt lgkmcnt(0)
    v_add_f32 v132, v36, v116
    v_mfma_f32_32x32x16_bf16 v[80:95], a[100:103], v[224:227], v[80:95]
    v_add_f32 v133, v37, v117
    v_add_f32 v134, v38, v118
    v_add_f32 v135, v39, v119
    v_add_f32 v128, v128, v96
    v_add_f32 v129, v129, v97
    s_waitcnt vmcnt(11)
    v_mfma_f32_32x32x16_bf16 v[64:79], a[104:107], v[228:231], v[64:79]
    buffer_load_dwordx4 v[176:179], v22, s[56:59], s86 offen offset:1024 sc1
    v_add_f32 v130, v130, v98
    v_add_f32 v131, v131, v99
    v_add_f32 v132, v132, v100
    v_add_f32 v133, v133, v101
    v_mfma_f32_32x32x16_bf16 v[80:95], a[108:111], v[228:231], v[80:95]
    v_add_f32 v134, v134, v102
    v_add_f32 v135, v135, v103
    s_waitcnt vmcnt(11)
    v_mfma_f32_32x32x16_bf16 v[64:79], a[112:115], v[232:235], v[64:79]
    buffer_load_dwordx4 v[180:183], v22, s[56:59], s86 offen offset:3072 sc1
    v_mfma_f32_32x32x16_bf16 v[80:95], a[116:119], v[232:235], v[80:95]
    s_waitcnt vmcnt(11)
    v_mfma_f32_32x32x16_bf16 v[64:79], a[120:123], v[236:239], v[64:79]
    buffer_load_dwordx4 v[184:187], v22, s[56:59], s87 offen offset:1024 sc1
    v_mfma_f32_32x32x16_bf16 v[80:95], a[124:127], v[236:239], v[80:95]
    s_waitcnt vmcnt(11)
    v_mfma_f32_32x32x16_bf16 v[64:79], a[128:131], v[240:243], v[64:79]
    buffer_load_dwordx4 v[188:191], v22, s[56:59], s87 offen offset:3072 sc1
    v_mfma_f32_32x32x16_bf16 v[80:95], a[132:135], v[240:243], v[80:95]
    s_waitcnt vmcnt(11)
    v_mfma_f32_32x32x16_bf16 v[64:79], a[136:139], v[244:247], v[64:79]
    v_mfma_f32_32x32x16_bf16 v[80:95], a[140:143], v[244:247], v[80:95]
    s_waitcnt vmcnt(10)
    v_mfma_f32_32x32x16_bf16 v[64:79], a[144:147], v[248:251], v[64:79]
    s_waitcnt vmcnt(9)
    v_cmp_eq_u64 vcc, s[72:73], v[24:25]
    s_nop 0
    s_cmp_eq_u64 vcc, exec
    s_cbranch_scc1 L_ok_11
    s_mov_b32 s100, 0
    L_lp_12:
    buffer_load_dwordx2 v[24:25], v23, s[56:59], s14 offen sc1
    s_waitcnt vmcnt(0)
    v_cmp_eq_u64 vcc, s[72:73], v[24:25]
    s_add_u32 s100, s100, 1
    s_nop 1
    s_cmp_eq_u64 vcc, exec
    s_cbranch_scc1 L_ok_11
    s_sleep 4
    s_cmp_lt_u32 s100, 200000
    s_cbranch_scc1 L_lp_12
L_ok_11:
    v_lshrrev_b32 v28, 3, v0
    v_lshlrev_b32 v28, 12, v28
    v_mfma_f32_32x32x16_bf16 v[80:95], a[148:151], v[248:251], v[80:95]
    v_and_b32 v29, 7, v0
    v_lshl_add_u32 v28, v29, 4, v28
    v_add_u32 v29, 31744, v28
    s_lshl_b32 s5, s98, 18
    s_lshl_b32 s6, s10, 16
    s_waitcnt vmcnt(8)
    v_mfma_f32_32x32x16_bf16 v[64:79], a[152:155], v[252:255], v[64:79]
    s_add_u32 s5, s5, s6
    s_lshl_b32 s6, s97, 7
    s_add_u32 s5, s5, s6
    s_add_u32 s5, s5, 11534336
    s_lshl_b32 s6, s10, 11
    v_mfma_f32_32x32x16_bf16 v[80:95], a[156:159], v[252:255], v[80:95]
    s_add_u32 m0, s6, 155648
    s_nop 0
    buffer_load_dwordx4 v28, s[56:59], s5 offen offset:0 sc1 lds
    buffer_load_dwordx4 v29, s[56:59], s5 offen offset:1024 sc1 lds
    v_and_b32 v28, 31, v0
    v_lshlrev_b32 v28, 10, v28
    s_waitcnt vmcnt(9)
    v_mfma_f32_32x32x16_bf16 v[64:79], a[160:163], v[160:163], v[64:79]
    v_lshrrev_b32 v29, 5, v0
    v_lshl_or_b32 v158, v29, 4, v28
    s_lshl_b32 s15, s97, 16
    s_lshl_b32 s5, s98, 7
    s_add_u32 s15, s15, s5
    v_mfma_f32_32x32x16_bf16 v[80:95], a[164:167], v[160:163], v[80:95]
    s_lshl_b32 s5, s10, 5
    s_add_u32 s15, s15, s5
    s_add_u32 s9, s15, 32768
    s_waitcnt vmcnt(8)
    v_mfma_f32_32x32x16_bf16 v[64:79], a[168:171], v[164:167], v[64:79]
    v_mfma_f32_32x32x16_bf16 v[80:95], a[172:175], v[164:167], v[80:95]
    s_waitcnt vmcnt(7)
    v_mfma_f32_32x32x16_bf16 v[64:79], a[176:179], v[168:171], v[64:79]
    v_mfma_f32_32x32x16_bf16 v[80:95], a[180:183], v[168:171], v[80:95]
    s_waitcnt vmcnt(6)
    v_mfma_f32_32x32x16_bf16 v[64:79], a[184:187], v[172:175], v[64:79]
    v_mfma_f32_32x32x16_bf16 v[80:95], a[188:191], v[172:175], v[80:95]
    s_waitcnt vmcnt(5)
    v_mfma_f32_32x32x16_bf16 v[64:79], a[192:195], v[176:179], v[64:79]
    v_mfma_f32_32x32x16_bf16 v[80:95], a[196:199], v[176:179], v[80:95]
    s_waitcnt vmcnt(4)
    v_mfma_f32_32x32x16_bf16 v[64:79], a[200:203], v[180:183], v[64:79]
    v_mfma_f32_32x32x16_bf16 v[80:95], a[204:207], v[180:183], v[80:95]
    v_lshrrev_b32 v28, 5, v0
    v_bfe_u32 v29, v0, 2, 2
    v_lshl_or_b32 v28, v28, 2, v29
    v_lshlrev_b32 v28, 7, v28
    v_bfe_u32 v29, v0, 4, 1
    s_waitcnt vmcnt(3)
    v_mfma_f32_32x32x16_bf16 v[64:79], a[208:211], v[184:187], v[64:79]
    v_lshl_or_b32 v28, v29, 5, v28
    v_and_b32 v29, 3, v0
    v_lshl_or_b32 v28, v29, 3, v28
    s_lshl_b32 s6, s10, 11
    s_add_u32 s6, s6, 155648
    v_mfma_f32_32x32x16_bf16 v[80:95], a[212:215], v[184:187], v[80:95]
    v_add_u32 v28, s6, v28
    v_bfe_u32 v29, v0, 1, 3
    s_lshl_b32 s6, s10, 1
    v_xor_b32 v29, s6, v29
    v_and_b32 v30, 31, v0
    s_waitcnt vmcnt(2)
    v_mfma_f32_32x32x16_bf16 v[64:79], a[216:219], v[188:191], v[64:79]
    v_lshlrev_b32 v30, 7, v30
    v_lshrrev_b32 v31, 5, v0
    v_lshl_or_b32 v30, v31, 3, v30
    v_add_u32 v30, 147456, v30
    v_xor_b32 v31, 1, v29
    v_mfma_f32_32x32x16_bf16 v[80:95], a[220:223], v[188:191], v[80:95]
    v_lshl_add_u32 v29, v29, 4, v30
    v_lshl_add_u32 v30, v31, 4, v30
    s_waitcnt vmcnt(0)
    ds_read_b64 v[120:121], v29 offset:0
    ds_read_b64_tr_b16 v[124:125], v28 offset:0
    ds_read_b64 v[122:123], v30 offset:0
    ds_read_b64_tr_b16 v[126:127], v28 offset:1024
    v_lshlrev_b32 v31, 16, v152
    v_and_b32 v152, s99, v152
    s_waitcnt lgkmcnt(3)
    v_lshlrev_b32 v136, 16, v120
    v_and_b32 v137, s99, v120
    s_waitcnt lgkmcnt(2)
    v_lshlrev_b32 v120, 16, v124
    v_and_b32 v124, s99, v124
    v_mul_f32 v136, v136, v120
    v_mul_f32 v137, v137, v124
    v_mul_f32 v136, v136, v31
    v_mul_f32 v137, v137, v31
    v_lshlrev_b32 v138, 16, v121
    v_and_b32 v139, s99, v121
    v_lshlrev_b32 v121, 16, v125
    v_and_b32 v125, s99, v125
    v_mul_f32 v138, v138, v121
    v_mul_f32 v139, v139, v125
    v_mul_f32 v138, v138, v31
    v_mul_f32 v139, v139, v31
    s_waitcnt lgkmcnt(1)
    v_lshlrev_b32 v140, 16, v122
    v_and_b32 v141, s99, v122
    s_waitcnt lgkmcnt(0)
    v_lshlrev_b32 v122, 16, v126
    v_and_b32 v126, s99, v126
    v_mul_f32 v140, v140, v122
    v_mul_f32 v141, v141, v126
    v_mul_f32 v140, v140, v31
    v_mul_f32 v141, v141, v31
    v_lshlrev_b32 v142, 16, v123
    v_and_b32 v143, s99, v123
    v_lshlrev_b32 v123, 16, v127
    v_and_b32 v127, s99, v127
    v_mul_f32 v142, v142, v123
    v_mul_f32 v143, v143, v127
    v_mul_f32 v142, v142, v31
    v_mul_f32 v143, v143, v31
    ds_read_b64 v[120:121], v29 offset:4096
    ds_read_b64_tr_b16 v[124:125], v28 offset:64
    ds_read_b64 v[122:123], v30 offset:4096
    ds_read_b64_tr_b16 v[126:127], v28 offset:1088
    v_lshlrev_b32 v31, 16, v153
    v_and_b32 v153, s99, v153
    s_waitcnt lgkmcnt(3)
    v_lshlrev_b32 v144, 16, v120
    v_and_b32 v145, s99, v120
    s_waitcnt lgkmcnt(2)
    v_lshlrev_b32 v120, 16, v124
    v_and_b32 v124, s99, v124
    v_mul_f32 v144, v144, v120
    v_mul_f32 v145, v145, v124
    v_mul_f32 v144, v144, v31
    v_mul_f32 v145, v145, v31
    v_lshlrev_b32 v146, 16, v121
    v_and_b32 v147, s99, v121
    v_lshlrev_b32 v121, 16, v125
    v_and_b32 v125, s99, v125
    v_mul_f32 v146, v146, v121
    v_mul_f32 v147, v147, v125
    v_mul_f32 v146, v146, v31
    v_mul_f32 v147, v147, v31
    s_waitcnt lgkmcnt(1)
    v_lshlrev_b32 v148, 16, v122
    v_and_b32 v149, s99, v122
    s_waitcnt lgkmcnt(0)
    v_lshlrev_b32 v122, 16, v126
    v_and_b32 v126, s99, v126
    v_mul_f32 v148, v148, v122
    v_mul_f32 v149, v149, v126
    v_mul_f32 v148, v148, v31
    v_mul_f32 v149, v149, v31
    v_lshlrev_b32 v150, 16, v123
    v_and_b32 v151, s99, v123
    v_lshlrev_b32 v123, 16, v127
    v_and_b32 v127, s99, v127
    v_mul_f32 v150, v150, v123
    v_mul_f32 v151, v151, v127
    v_mul_f32 v150, v150, v31
    v_mul_f32 v151, v151, v31
    ds_write_b128 v154, v[72:75] offset:32768
    ds_write_b128 v154, v[76:79] offset:33792
    ds_write_b128 v155, v[80:83] offset:34816
    ds_write_b128 v155, v[84:87] offset:35840
    ds_write_b128 v156, v[88:91] offset:36864
    ds_write_b128 v156, v[92:95] offset:37888
    v_fmac_f32 v136, v152, v128
    v_fmac_f32 v137, v152, v129
    v_fmac_f32 v138, v152, v130
    v_fmac_f32 v139, v152, v131
    v_fmac_f32 v140, v152, v132
    v_fmac_f32 v141, v152, v133
    v_fmac_f32 v142, v152, v134
    v_fmac_f32 v143, v152, v135
    v_cvt_pk_bf16_f32 v128, v136, v137
    v_cvt_pk_bf16_f32 v129, v138, v139
    v_cvt_pk_bf16_f32 v130, v140, v141
    v_cvt_pk_bf16_f32 v131, v142, v143
    s_nop 0
    v_permlane32_swap_b32 v128, v130
    v_permlane32_swap_b32 v129, v131
    buffer_store_dwordx4 v[128:131], v158, s[68:71], s15 offen
    s_waitcnt lgkmcnt(0)
    s_barrier
    ds_read_b128 v[96:99], v157 offset:32768
    ds_read_b128 v[100:103], v157 offset:33792
    ds_read_b128 v[104:107], v157 offset:34816
    ds_read_b128 v[108:111], v157 offset:35840
    ds_read_b128 v[112:115], v157 offset:36864
    ds_read_b128 v[116:119], v157 offset:37888
    s_waitcnt lgkmcnt(3)
    v_add_f32 v96, v96, v104
    v_add_f32 v97, v97, v105
    v_add_f32 v98, v98, v106
    v_add_f32 v99, v99, v107
    s_waitcnt lgkmcnt(2)
    v_add_f32 v100, v100, v108
    v_add_f32 v101, v101, v109
    v_add_f32 v102, v102, v110
    v_add_f32 v103, v103, v111
    s_waitcnt lgkmcnt(1)
    v_add_f32 v128, v64, v112
    v_add_f32 v129, v65, v113
    v_add_f32 v130, v66, v114
    v_add_f32 v131, v67, v115
    s_waitcnt lgkmcnt(0)
    v_add_f32 v132, v68, v116
    v_add_f32 v133, v69, v117
    v_add_f32 v134, v70, v118
    v_add_f32 v135, v71, v119
    v_add_f32 v128, v128, v96
    v_add_f32 v129, v129, v97
    v_add_f32 v130, v130, v98
    v_add_f32 v131, v131, v99
    v_add_f32 v132, v132, v100
    v_add_f32 v133, v133, v101
    v_add_f32 v134, v134, v102
    v_add_f32 v135, v135, v103
    v_fmac_f32 v144, v153, v128
    v_fmac_f32 v145, v153, v129
    v_fmac_f32 v146, v153, v130
    v_fmac_f32 v147, v153, v131
    v_fmac_f32 v148, v153, v132
    v_fmac_f32 v149, v153, v133
    v_fmac_f32 v150, v153, v134
    v_fmac_f32 v151, v153, v135
    v_cvt_pk_bf16_f32 v128, v144, v145
    v_cvt_pk_bf16_f32 v129, v146, v147
    v_cvt_pk_bf16_f32 v130, v148, v149
    v_cvt_pk_bf16_f32 v131, v150, v151
    s_nop 0
    v_permlane32_swap_b32 v128, v130
    v_permlane32_swap_b32 v129, v131
    buffer_store_dwordx4 v[128:131], v158, s[68:71], s9 offen
L_end:
    s_endpgm
L_helper:
    s_and_b32 s8, s2, 7
    s_lshr_b32 s9, s2, 3
    v_lshrrev_b32 v28, 3, v0
    v_and_b32 v29, 7, v0
    v_lshlrev_b32 v30, 10, v28
    v_lshl_add_u32 v32, v29, 4, v30
    s_lshl_b32 s11, s9, 19
    s_lshl_b32 s12, s88, 15
    s_add_u32 s12, s12, s11
    s_mul_i32 s10, s88, 4352
    v_bfrev_b32 v31, 1
    v_cmp_gt_u32 vcc, 5, v28
    s_nop 1
    v_cndmask_b32 v33, v32, v31, vcc
    s_cmp_eq_u32 s9, 0
    s_cselect_b32 s13, 0x80000000, 0
    v_or_b32 v37, s13, v33
    s_cselect_b32 s13, 0, 8192
    s_sub_u32 s13, s11, s13
    v_lshlrev_b32 v30, 6, v28
    s_and_b32 s14, s88, 1
    s_lshl_b32 s14, s14, 5
    v_add_u32 v30, s14, v30
    s_waitcnt lgkmcnt(0)
    s_mov_b64 s[48:49], s[18:19]
    s_mov_b32 s50, 2097152
    s_mov_b32 s51, 0x20000
    s_mov_b64 s[52:53], s[20:21]
    s_mov_b32 s54, 2097152
    s_mov_b32 s55, 0x20000
    s_add_u32 s15, s8, 0
    s_and_b32 s15, s15, 7
    s_lshl_b32 s15, s15, 7
    s_cmp_lg_u32 s88, 0
    s_cbranch_scc1 L_h0_13
    s_add_u32 s14, s13, s15
    s_mov_b32 m0, 0
    s_nop 0
    buffer_load_dwordx4 v37, s[48:51], s14 offen nt lds
    L_h0_13:
    s_add_u32 s15, s15, s12
    s_add_u32 m0, s10, 1088
    s_add_u32 s14, s15, 0
    buffer_load_dwordx4 v32, s[48:51], s14 offen nt lds
    s_add_u32 m0, s10, 73984
    s_nop 0
    buffer_load_dwordx4 v32, s[52:55], s14 offen nt lds
    s_add_u32 m0, s10, 2176
    s_add_u32 s14, s15, 8192
    buffer_load_dwordx4 v32, s[48:51], s14 offen nt lds
    s_add_u32 m0, s10, 75072
    s_nop 0
    buffer_load_dwordx4 v32, s[52:55], s14 offen nt lds
    s_add_u32 m0, s10, 3264
    s_add_u32 s14, s15, 16384
    buffer_load_dwordx4 v32, s[48:51], s14 offen nt lds
    s_add_u32 m0, s10, 76160
    s_nop 0
    buffer_load_dwordx4 v32, s[52:55], s14 offen nt lds
    s_add_u32 m0, s10, 4352
    s_add_u32 s14, s15, 24576
    buffer_load_dwordx4 v32, s[48:51], s14 offen nt lds
    s_add_u32 m0, s10, 77248
    s_nop 0
    buffer_load_dwordx4 v32, s[52:55], s14 offen nt lds
    s_add_u32 s5, s8, 0
    s_and_b32 s5, s5, 7
    s_lshl_b32 s5, s5, 9
    v_add_u32 v31, s5, v30
    global_load_dwordx4 v[56:59], v31, s[22:23] offset:0
    global_load_dwordx4 v[60:63], v31, s[22:23] offset:16
    s_mov_b64 s[56:57], s[42:43]
    s_mov_b32 s58, 14680064
    s_mov_b32 s59, 0x20000
    s_mov_b64 s[44:45], s[16:17]
    s_mov_b32 s46, 2097152
    s_mov_b32 s47, 0x20000
    s_or_b32 s3, s2, s88
    s_cmp_lg_u32 s3, 0
    s_cbranch_scc1 L_np_14
    v_mov_b32 v28, 14024704
    buffer_load_dwordx2 v[24:25], v28, s[56:59], 0 offen sc1
    s_waitcnt vmcnt(0)
    v_add_u32 v24, 0x9E3779B8, v24
    v_or_b32 v24, 1, v24
    v_add_u32 v25, 0x7F4A7C15, v25
    v_mov_b32 v28, 0
    s_mov_b64 exec, 1
    global_store_dwordx2 v28, v[24:25], s[40:41] sc1
    s_mov_b64 exec, -1
L_np_14:
    s_add_u32 s15, s8, 1
    s_and_b32 s15, s15, 7
    s_lshl_b32 s15, s15, 7
    s_cmp_lg_u32 s88, 0
    s_cbranch_scc1 L_h0_15
    s_add_u32 s14, s11, s15
    s_add_u32 s14, s14, 122880
    s_mov_b32 m0, 18496
    s_nop 0
    buffer_load_dwordx4 v33, s[48:51], s14 offen nt lds
    L_h0_15:
    s_add_u32 s15, s15, s12
    s_add_u32 m0, s10, 19584
    s_add_u32 s14, s15, 131072
    buffer_load_dwordx4 v32, s[48:51], s14 offen nt lds
    s_add_u32 m0, s10, 91392
    s_nop 0
    buffer_load_dwordx4 v32, s[52:55], s14 offen nt lds
    s_add_u32 m0, s10, 20672
    s_add_u32 s14, s15, 139264
    buffer_load_dwordx4 v32, s[48:51], s14 offen nt lds
    s_add_u32 m0, s10, 92480
    s_nop 0
    buffer_load_dwordx4 v32, s[52:55], s14 offen nt lds
    s_add_u32 m0, s10, 21760
    s_add_u32 s14, s15, 147456
    buffer_load_dwordx4 v32, s[48:51], s14 offen nt lds
    s_add_u32 m0, s10, 93568
    s_nop 0
    buffer_load_dwordx4 v32, s[52:55], s14 offen nt lds
    s_add_u32 m0, s10, 22848
    s_add_u32 s14, s15, 155648
    buffer_load_dwordx4 v32, s[48:51], s14 offen nt lds
    s_add_u32 m0, s10, 94656
    s_nop 0
    buffer_load_dwordx4 v32, s[52:55], s14 offen nt lds
    s_add_u32 s5, s8, 1
    s_and_b32 s5, s5, 7
    s_lshl_b32 s5, s5, 9
    v_add_u32 v31, s5, v30
    global_load_dwordx4 v[64:67], v31, s[22:23] offset:0
    global_load_dwordx4 v[68:71], v31, s[22:23] offset:16
    s_add_u32 s5, s8, 2
    s_and_b32 s5, s5, 7
    s_lshl_b32 s5, s5, 9
    v_add_u32 v31, s5, v30
    global_load_dwordx4 v[72:75], v31, s[22:23] offset:0
    global_load_dwordx4 v[76:79], v31, s[22:23] offset:16
    s_add_u32 s5, s8, 3
    s_and_b32 s5, s5, 7
    s_lshl_b32 s5, s5, 9
    v_add_u32 v31, s5, v30
    global_load_dwordx4 v[80:83], v31, s[22:23] offset:0
    global_load_dwordx4 v[84:87], v31, s[22:23] offset:16
    s_cmp_lg_u32 s88, 3
    s_cbranch_scc1 L_pf_16
    s_getpc_b64 s[6:7]
L_pc_17:
    s_sub_u32 s6, s6, L_pc_17-gated_mix__ssm_conv_h3__glu_gated_reglu__prompt_kernel
    s_subb_u32 s7, s7, 0
    s_lshr_b32 s3, s2, 3
    s_and_b32 s3, s3, 7
    s_mul_i32 s3, s3, 5120
    v_min_u32 v28, 39, v0
    v_lshlrev_b32 v28, 7, v28
    v_add_u32 v28, s3, v28
    v_min_u32 v28, L_codeend-gated_mix__ssm_conv_h3__glu_gated_reglu__prompt_kernel-4, v28
    global_load_dword v127, v28, s[6:7]
L_pf_16:
    v_lshrrev_b32 v28, 3, v0
    v_and_b32 v29, 7, v0
    s_lshr_b32 s3, s88, 1
    s_and_b32 s4, s88, 1
    s_mul_i32 s5, s3, 8704
    s_lshl_b32 s6, s4, 3
    s_add_u32 s5, s5, s6
    v_mul_u32_u24 v31, 1088, v29
    v_lshl_add_u32 v31, v28, 4, v31
    v_add_u32 v34, s5, v31
    v_add_u32 v35, 73984, v34
    v_lshlrev_b32 v30, 15, v28
    v_lshl_add_u32 v30, v29, 4, v30
    s_lshl_b32 s5, s4, 14
    s_lshl_b32 s6, s3, 7
    s_add_u32 s5, s5, s6
    v_add_u32 v36, s5, v30
    s_lshl_b32 s4, s9, 10
    s_add_u32 s4, s4, 9437184
    s_waitcnt vmcnt(16)
    s_barrier
    ds_read_b64 v[128:129], v34 offset:640
    ds_read_b64 v[130:131], v34 offset:768
    ds_read_b64 v[132:133], v34 offset:896
    ds_read_b64 v[134:135], v34 offset:1088
    ds_read_b64 v[150:151], v35 offset:0
    ds_read_b64 v[136:137], v34 offset:1216
    ds_read_b64 v[152:153], v35 offset:128
    ds_read_b64 v[138:139], v34 offset:1344
    ds_read_b64 v[154:155], v35 offset:256
    ds_read_b64 v[140:141], v34 offset:1472
    ds_read_b64 v[156:157], v35 offset:384
    ds_read_b64 v[142:143], v34 offset:1600
    ds_read_b64 v[158:159], v35 offset:512
    ds_read_b64 v[144:145], v34 offset:1728
    ds_read_b64 v[160:161], v35 offset:640
    s_waitcnt lgkmcnt(14)
    ds_read_b64 v[146:147], v34 offset:1856
    s_waitcnt lgkmcnt(14)
    ds_read_b64 v[162:163], v35 offset:768
    s_waitcnt lgkmcnt(14)
    ds_read_b64 v[148:149], v34 offset:1984
    s_waitcnt lgkmcnt(14)
    ds_read_b64 v[164:165], v35 offset:896
    s_add_u32 s15, s8, 2
    s_and_b32 s15, s15, 7
    s_lshl_b32 s15, s15, 7
    s_waitcnt vmcnt(15)
    v_lshlrev_b32 v40, 16, v56
    v_and_b32 v44, s99, v56
    v_lshlrev_b32 v48, 16, v57
    v_and_b32 v52, s99, v57
    v_lshlrev_b32 v41, 16, v58
    v_and_b32 v45, s99, v58
    v_lshlrev_b32 v49, 16, v59
    v_and_b32 v53, s99, v59
    s_waitcnt vmcnt(14)
    v_lshlrev_b32 v42, 16, v60
    v_and_b32 v46, s99, v60
    v_lshlrev_b32 v50, 16, v61
    v_and_b32 v54, s99, v61
    v_lshlrev_b32 v43, 16, v62
    v_and_b32 v47, s99, v62
    v_lshlrev_b32 v51, 16, v63
    v_and_b32 v55, s99, v63
    v_lshlrev_b32 v172, 16, v128
    v_and_b32 v173, s99, v128
    s_cmp_lg_u32 s88, 0
    s_cbranch_scc1 L_h0_18
    s_add_u32 s14, s11, s15
    s_add_u32 s14, s14, 253952
    s_mov_b32 m0, 36992
    s_nop 0
    buffer_load_dwordx4 v33, s[48:51], s14 offen nt lds
    L_h0_18:
    s_add_u32 s15, s15, s12
    v_lshlrev_b32 v174, 16, v129
    v_and_b32 v175, s99, v129
    v_lshlrev_b32 v176, 16, v130
    v_and_b32 v177, s99, v130
    v_lshlrev_b32 v178, 16, v131
    v_and_b32 v179, s99, v131
    v_lshlrev_b32 v180, 16, v132
    v_and_b32 v181, s99, v132
    v_lshlrev_b32 v182, 16, v133
    v_and_b32 v183, s99, v133
    v_lshlrev_b32 v168, 16, v134
    v_and_b32 v169, s99, v134
    v_lshlrev_b32 v170, 16, v135
    v_and_b32 v171, s99, v135
    s_waitcnt lgkmcnt(14)
    v_lshlrev_b32 v184, 16, v150
    v_and_b32 v185, s99, v150
    v_lshlrev_b32 v186, 16, v151
    v_and_b32 v187, s99, v151
    s_add_u32 m0, s10, 38080
    s_add_u32 s14, s15, 262144
    buffer_load_dwordx4 v32, s[48:51], s14 offen nt lds
    v_pk_mul_f32 v[188:189], v[172:173], v[52:53]
    v_pk_mul_f32 v[190:191], v[174:175], v[54:55]
    v_pk_fma_f32 v[188:189], v[176:177], v[48:49], v[188:189]
    v_pk_fma_f32 v[190:191], v[178:179], v[50:51], v[190:191]
    v_pk_fma_f32 v[188:189], v[180:181], v[44:45], v[188:189]
    v_pk_fma_f32 v[190:191], v[182:183], v[46:47], v[190:191]
    v_pk_fma_f32 v[188:189], v[168:169], v[40:41], v[188:189]
    v_pk_fma_f32 v[190:191], v[170:171], v[42:43], v[190:191]
    v_pk_mul_f32 v[188:189], v[188:189], v[184:185]
    v_pk_mul_f32 v[190:191], v[190:191], v[186:187]
    s_waitcnt lgkmcnt(13)
    v_lshlrev_b32 v172, 16, v136
    v_and_b32 v173, s99, v136
    v_lshlrev_b32 v174, 16, v137
    v_and_b32 v175, s99, v137
    s_waitcnt lgkmcnt(12)
    v_lshlrev_b32 v184, 16, v152
    v_and_b32 v185, s99, v152
    v_lshlrev_b32 v186, 16, v153
    v_and_b32 v187, s99, v153
    s_add_u32 m0, s10, 108800
    s_nop 0
    buffer_load_dwordx4 v32, s[52:55], s14 offen nt lds
    v_pk_mul_f32 v[192:193], v[176:177], v[52:53]
    v_pk_mul_f32 v[194:195], v[178:179], v[54:55]
    v_pk_fma_f32 v[192:193], v[180:181], v[48:49], v[192:193]
    v_pk_fma_f32 v[194:195], v[182:183], v[50:51], v[194:195]
    v_pk_fma_f32 v[192:193], v[168:169], v[44:45], v[192:193]
    v_pk_fma_f32 v[194:195], v[170:171], v[46:47], v[194:195]
    v_pk_fma_f32 v[192:193], v[172:173], v[40:41], v[192:193]
    v_pk_fma_f32 v[194:195], v[174:175], v[42:43], v[194:195]
    v_pk_mul_f32 v[192:193], v[192:193], v[184:185]
    v_pk_mul_f32 v[194:195], v[194:195], v[186:187]
    v_cvt_pk_bf16_f32 v199, v192, v188
    v_cvt_pk_bf16_f32 v203, v193, v189
    v_cvt_pk_bf16_f32 v207, v194, v190
    v_cvt_pk_bf16_f32 v211, v195, v191
    s_waitcnt lgkmcnt(11)
    v_lshlrev_b32 v176, 16, v138
    v_and_b32 v177, s99, v138
    v_lshlrev_b32 v178, 16, v139
    v_and_b32 v179, s99, v139
    s_add_u32 m0, s10, 39168
    s_add_u32 s14, s15, 270336
    buffer_load_dwordx4 v32, s[48:51], s14 offen nt lds
    s_waitcnt lgkmcnt(10)
    v_lshlrev_b32 v184, 16, v154
    v_and_b32 v185, s99, v154
    v_lshlrev_b32 v186, 16, v155
    v_and_b32 v187, s99, v155
    v_pk_mul_f32 v[188:189], v[180:181], v[52:53]
    v_pk_mul_f32 v[190:191], v[182:183], v[54:55]
    v_pk_fma_f32 v[188:189], v[168:169], v[48:49], v[188:189]
    v_pk_fma_f32 v[190:191], v[170:171], v[50:51], v[190:191]
    v_pk_fma_f32 v[188:189], v[172:173], v[44:45], v[188:189]
    v_pk_fma_f32 v[190:191], v[174:175], v[46:47], v[190:191]
    v_pk_fma_f32 v[188:189], v[176:177], v[40:41], v[188:189]
    v_pk_fma_f32 v[190:191], v[178:179], v[42:43], v[190:191]
    v_pk_mul_f32 v[188:189], v[188:189], v[184:185]
    v_pk_mul_f32 v[190:191], v[190:191], v[186:187]
    s_waitcnt lgkmcnt(9)
    v_lshlrev_b32 v180, 16, v140
    v_and_b32 v181, s99, v140
    v_lshlrev_b32 v182, 16, v141
    v_and_b32 v183, s99, v141
    s_add_u32 m0, s10, 109888
    s_nop 0
    buffer_load_dwordx4 v32, s[52:55], s14 offen nt lds
    s_waitcnt lgkmcnt(8)
    v_lshlrev_b32 v184, 16, v156
    v_and_b32 v185, s99, v156
    v_lshlrev_b32 v186, 16, v157
    v_and_b32 v187, s99, v157
    v_pk_mul_f32 v[192:193], v[168:169], v[52:53]
    v_pk_mul_f32 v[194:195], v[170:171], v[54:55]
    v_pk_fma_f32 v[192:193], v[172:173], v[48:49], v[192:193]
    v_pk_fma_f32 v[194:195], v[174:175], v[50:51], v[194:195]
    v_pk_fma_f32 v[192:193], v[176:177], v[44:45], v[192:193]
    v_pk_fma_f32 v[194:195], v[178:179], v[46:47], v[194:195]
    v_pk_fma_f32 v[192:193], v[180:181], v[40:41], v[192:193]
    v_pk_fma_f32 v[194:195], v[182:183], v[42:43], v[194:195]
    v_pk_mul_f32 v[192:193], v[192:193], v[184:185]
    v_pk_mul_f32 v[194:195], v[194:195], v[186:187]
    v_cvt_pk_bf16_f32 v198, v192, v188
    v_cvt_pk_bf16_f32 v202, v193, v189
    v_cvt_pk_bf16_f32 v206, v194, v190
    v_cvt_pk_bf16_f32 v210, v195, v191
    s_add_u32 m0, s10, 40256
    s_add_u32 s14, s15, 278528
    buffer_load_dwordx4 v32, s[48:51], s14 offen nt lds
    s_waitcnt lgkmcnt(7)
    v_lshlrev_b32 v168, 16, v142
    v_and_b32 v169, s99, v142
    v_lshlrev_b32 v170, 16, v143
    v_and_b32 v171, s99, v143
    s_waitcnt lgkmcnt(6)
    v_lshlrev_b32 v184, 16, v158
    v_and_b32 v185, s99, v158
    v_lshlrev_b32 v186, 16, v159
    v_and_b32 v187, s99, v159
    v_pk_mul_f32 v[188:189], v[172:173], v[52:53]
    v_pk_mul_f32 v[190:191], v[174:175], v[54:55]
    v_pk_fma_f32 v[188:189], v[176:177], v[48:49], v[188:189]
    v_pk_fma_f32 v[190:191], v[178:179], v[50:51], v[190:191]
    v_pk_fma_f32 v[188:189], v[180:181], v[44:45], v[188:189]
    v_pk_fma_f32 v[190:191], v[182:183], v[46:47], v[190:191]
    v_pk_fma_f32 v[188:189], v[168:169], v[40:41], v[188:189]
    v_pk_fma_f32 v[190:191], v[170:171], v[42:43], v[190:191]
    v_pk_mul_f32 v[188:189], v[188:189], v[184:185]
    v_pk_mul_f32 v[190:191], v[190:191], v[186:187]
    s_add_u32 m0, s10, 110976
    s_nop 0
    buffer_load_dwordx4 v32, s[52:55], s14 offen nt lds
    s_waitcnt lgkmcnt(5)
    v_lshlrev_b32 v172, 16, v144
    v_and_b32 v173, s99, v144
    v_lshlrev_b32 v174, 16, v145
    v_and_b32 v175, s99, v145
    s_waitcnt lgkmcnt(4)
    v_lshlrev_b32 v184, 16, v160
    v_and_b32 v185, s99, v160
    v_lshlrev_b32 v186, 16, v161
    v_and_b32 v187, s99, v161
    v_pk_mul_f32 v[192:193], v[176:177], v[52:53]
    v_pk_mul_f32 v[194:195], v[178:179], v[54:55]
    v_pk_fma_f32 v[192:193], v[180:181], v[48:49], v[192:193]
    v_pk_fma_f32 v[194:195], v[182:183], v[50:51], v[194:195]
    v_pk_fma_f32 v[192:193], v[168:169], v[44:45], v[192:193]
    v_pk_fma_f32 v[194:195], v[170:171], v[46:47], v[194:195]
    v_pk_fma_f32 v[192:193], v[172:173], v[40:41], v[192:193]
    v_pk_fma_f32 v[194:195], v[174:175], v[42:43], v[194:195]
    v_pk_mul_f32 v[192:193], v[192:193], v[184:185]
    v_pk_mul_f32 v[194:195], v[194:195], v[186:187]
    s_add_u32 m0, s10, 41344
    s_add_u32 s14, s15, 286720
    buffer_load_dwordx4 v32, s[48:51], s14 offen nt lds
    v_cvt_pk_bf16_f32 v197, v192, v188
    v_cvt_pk_bf16_f32 v201, v193, v189
    v_cvt_pk_bf16_f32 v205, v194, v190
    v_cvt_pk_bf16_f32 v209, v195, v191
    s_waitcnt lgkmcnt(3)
    v_lshlrev_b32 v176, 16, v146
    v_and_b32 v177, s99, v146
    v_lshlrev_b32 v178, 16, v147
    v_and_b32 v179, s99, v147
    s_waitcnt lgkmcnt(2)
    v_lshlrev_b32 v184, 16, v162
    v_and_b32 v185, s99, v162
    v_lshlrev_b32 v186, 16, v163
    v_and_b32 v187, s99, v163
    v_pk_mul_f32 v[188:189], v[180:181], v[52:53]
    v_pk_mul_f32 v[190:191], v[182:183], v[54:55]
    v_pk_fma_f32 v[188:189], v[168:169], v[48:49], v[188:189]
    v_pk_fma_f32 v[190:191], v[170:171], v[50:51], v[190:191]
    v_pk_fma_f32 v[188:189], v[172:173], v[44:45], v[188:189]
    v_pk_fma_f32 v[190:191], v[174:175], v[46:47], v[190:191]
    s_add_u32 m0, s10, 112064
    s_nop 0
    buffer_load_dwordx4 v32, s[52:55], s14 offen nt lds
    v_pk_fma_f32 v[188:189], v[176:177], v[40:41], v[188:189]
    v_pk_fma_f32 v[190:191], v[178:179], v[42:43], v[190:191]
    v_pk_mul_f32 v[188:189], v[188:189], v[184:185]
    v_pk_mul_f32 v[190:191], v[190:191], v[186:187]
    s_waitcnt lgkmcnt(1)
    v_lshlrev_b32 v180, 16, v148
    v_and_b32 v181, s99, v148
    v_lshlrev_b32 v182, 16, v149
    v_and_b32 v183, s99, v149
    s_waitcnt lgkmcnt(0)
    v_lshlrev_b32 v184, 16, v164
    v_and_b32 v185, s99, v164
    v_lshlrev_b32 v186, 16, v165
    v_and_b32 v187, s99, v165
    v_pk_mul_f32 v[192:193], v[168:169], v[52:53]
    v_pk_mul_f32 v[194:195], v[170:171], v[54:55]
    v_pk_fma_f32 v[192:193], v[172:173], v[48:49], v[192:193]
    v_pk_fma_f32 v[194:195], v[174:175], v[50:51], v[194:195]
    v_pk_fma_f32 v[192:193], v[176:177], v[44:45], v[192:193]
    v_pk_fma_f32 v[194:195], v[178:179], v[46:47], v[194:195]
    v_pk_fma_f32 v[192:193], v[180:181], v[40:41], v[192:193]
    v_pk_fma_f32 v[194:195], v[182:183], v[42:43], v[194:195]
    v_pk_mul_f32 v[192:193], v[192:193], v[184:185]
    v_pk_mul_f32 v[194:195], v[194:195], v[186:187]
    v_cvt_pk_bf16_f32 v196, v192, v188
    v_cvt_pk_bf16_f32 v200, v193, v189
    v_cvt_pk_bf16_f32 v204, v194, v190
    v_cvt_pk_bf16_f32 v208, v195, v191
    s_add_u32 s7, s8, 0
    s_and_b32 s7, s7, 7
    s_lshl_b32 s7, s7, 18
    s_add_u32 s7, s7, s4
    s_add_u32 s6, s7, 0
    buffer_store_dwordx4 v[196:199], v36, s[56:59], s6 offen sc1
    s_add_u32 s6, s7, 4096
    buffer_store_dwordx4 v[200:203], v36, s[56:59], s6 offen sc1
    s_add_u32 s6, s7, 8192
    buffer_store_dwordx4 v[204:207], v36, s[56:59], s6 offen sc1
    s_add_u32 s6, s7, 12288
    buffer_store_dwordx4 v[208:211], v36, s[56:59], s6 offen sc1
    v_mov_b32 v28, 0
    global_load_dwordx2 v[26:27], v28, s[40:41] sc1
    s_waitcnt vmcnt(19)
    s_barrier
    ds_read_b64 v[128:129], v34 offset:19136
    ds_read_b64 v[130:131], v34 offset:19264
    ds_read_b64 v[132:133], v34 offset:19392
    ds_read_b64 v[134:135], v34 offset:19584
    ds_read_b64 v[150:151], v35 offset:17408
    ds_read_b64 v[136:137], v34 offset:19712
    ds_read_b64 v[152:153], v35 offset:17536
    ds_read_b64 v[138:139], v34 offset:19840
    ds_read_b64 v[154:155], v35 offset:17664
    ds_read_b64 v[140:141], v34 offset:19968
    ds_read_b64 v[156:157], v35 offset:17792
    ds_read_b64 v[142:143], v34 offset:20096
    ds_read_b64 v[158:159], v35 offset:17920
    ds_read_b64 v[144:145], v34 offset:20224
    ds_read_b64 v[160:161], v35 offset:18048
    s_waitcnt lgkmcnt(14)
    ds_read_b64 v[146:147], v34 offset:20352
    s_waitcnt lgkmcnt(14)
    ds_read_b64 v[162:163], v35 offset:18176
    s_waitcnt lgkmcnt(14)
    ds_read_b64 v[148:149], v34 offset:20480
    s_waitcnt lgkmcnt(14)
    ds_read_b64 v[164:165], v35 offset:18304
    s_add_u32 s15, s8, 3
    s_and_b32 s15, s15, 7
    s_lshl_b32 s15, s15, 7
    s_waitcnt vmcnt(18)
    v_lshlrev_b32 v40, 16, v64
    v_and_b32 v44, s99, v64
    v_lshlrev_b32 v48, 16, v65
    v_and_b32 v52, s99, v65
    v_lshlrev_b32 v41, 16, v66
    v_and_b32 v45, s99, v66
    v_lshlrev_b32 v49, 16, v67
    v_and_b32 v53, s99, v67
    s_waitcnt vmcnt(17)
    v_lshlrev_b32 v42, 16, v68
    v_and_b32 v46, s99, v68
    v_lshlrev_b32 v50, 16, v69
    v_and_b32 v54, s99, v69
    v_lshlrev_b32 v43, 16, v70
    v_and_b32 v47, s99, v70
    v_lshlrev_b32 v51, 16, v71
    v_and_b32 v55, s99, v71
    v_lshlrev_b32 v172, 16, v128
    v_and_b32 v173, s99, v128
    s_cmp_lg_u32 s88, 0
    s_cbranch_scc1 L_h0_19
    s_add_u32 s14, s11, s15
    s_add_u32 s14, s14, 385024
    s_mov_b32 m0, 55488
    s_nop 0
    buffer_load_dwordx4 v33, s[48:51], s14 offen nt lds
    L_h0_19:
    s_add_u32 s15, s15, s12
    v_lshlrev_b32 v174, 16, v129
    v_and_b32 v175, s99, v129
    v_lshlrev_b32 v176, 16, v130
    v_and_b32 v177, s99, v130
    v_lshlrev_b32 v178, 16, v131
    v_and_b32 v179, s99, v131
    v_lshlrev_b32 v180, 16, v132
    v_and_b32 v181, s99, v132
    v_lshlrev_b32 v182, 16, v133
    v_and_b32 v183, s99, v133
    v_lshlrev_b32 v168, 16, v134
    v_and_b32 v169, s99, v134
    v_lshlrev_b32 v170, 16, v135
    v_and_b32 v171, s99, v135
    s_waitcnt lgkmcnt(14)
    v_lshlrev_b32 v184, 16, v150
    v_and_b32 v185, s99, v150
    v_lshlrev_b32 v186, 16, v151
    v_and_b32 v187, s99, v151
    s_add_u32 m0, s10, 56576
    s_add_u32 s14, s15, 393216
    buffer_load_dwordx4 v32, s[48:51], s14 offen nt lds
    v_pk_mul_f32 v[188:189], v[172:173], v[52:53]
    v_pk_mul_f32 v[190:191], v[174:175], v[54:55]
    v_pk_fma_f32 v[188:189], v[176:177], v[48:49], v[188:189]
    v_pk_fma_f32 v[190:191], v[178:179], v[50:51], v[190:191]
    v_pk_fma_f32 v[188:189], v[180:181], v[44:45], v[188:189]
    v_pk_fma_f32 v[190:191], v[182:183], v[46:47], v[190:191]
    v_pk_fma_f32 v[188:189], v[168:169], v[40:41], v[188:189]
    v_pk_fma_f32 v[190:191], v[170:171], v[42:43], v[190:191]
    v_pk_mul_f32 v[188:189], v[188:189], v[184:185]
    v_pk_mul_f32 v[190:191], v[190:191], v[186:187]
    s_waitcnt lgkmcnt(13)
    v_lshlrev_b32 v172, 16, v136
    v_and_b32 v173, s99, v136
    v_lshlrev_b32 v174, 16, v137
    v_and_b32 v175, s99, v137
    s_waitcnt lgkmcnt(12)
    v_lshlrev_b32 v184, 16, v152
    v_and_b32 v185, s99, v152
    v_lshlrev_b32 v186, 16, v153
    v_and_b32 v187, s99, v153
    s_add_u32 m0, s10, 126208
    s_nop 0
    buffer_load_dwordx4 v32, s[52:55], s14 offen nt lds
    v_pk_mul_f32 v[192:193], v[176:177], v[52:53]
    v_pk_mul_f32 v[194:195], v[178:179], v[54:55]
    v_pk_fma_f32 v[192:193], v[180:181], v[48:49], v[192:193]
    v_pk_fma_f32 v[194:195], v[182:183], v[50:51], v[194:195]
    v_pk_fma_f32 v[192:193], v[168:169], v[44:45], v[192:193]
    v_pk_fma_f32 v[194:195], v[170:171], v[46:47], v[194:195]
    v_pk_fma_f32 v[192:193], v[172:173], v[40:41], v[192:193]
    v_pk_fma_f32 v[194:195], v[174:175], v[42:43], v[194:195]
    v_pk_mul_f32 v[192:193], v[192:193], v[184:185]
    v_pk_mul_f32 v[194:195], v[194:195], v[186:187]
    v_cvt_pk_bf16_f32 v199, v192, v188
    v_cvt_pk_bf16_f32 v203, v193, v189
    v_cvt_pk_bf16_f32 v207, v194, v190
    v_cvt_pk_bf16_f32 v211, v195, v191
    s_waitcnt lgkmcnt(11)
    v_lshlrev_b32 v176, 16, v138
    v_and_b32 v177, s99, v138
    v_lshlrev_b32 v178, 16, v139
    v_and_b32 v179, s99, v139
    s_add_u32 m0, s10, 57664
    s_add_u32 s14, s15, 401408
    buffer_load_dwordx4 v32, s[48:51], s14 offen nt lds
    s_waitcnt lgkmcnt(10)
    v_lshlrev_b32 v184, 16, v154
    v_and_b32 v185, s99, v154
    v_lshlrev_b32 v186, 16, v155
    v_and_b32 v187, s99, v155
    v_pk_mul_f32 v[188:189], v[180:181], v[52:53]
    v_pk_mul_f32 v[190:191], v[182:183], v[54:55]
    v_pk_fma_f32 v[188:189], v[168:169], v[48:49], v[188:189]
    v_pk_fma_f32 v[190:191], v[170:171], v[50:51], v[190:191]
    v_pk_fma_f32 v[188:189], v[172:173], v[44:45], v[188:189]
    v_pk_fma_f32 v[190:191], v[174:175], v[46:47], v[190:191]
    v_pk_fma_f32 v[188:189], v[176:177], v[40:41], v[188:189]
    v_pk_fma_f32 v[190:191], v[178:179], v[42:43], v[190:191]
    v_pk_mul_f32 v[188:189], v[188:189], v[184:185]
    v_pk_mul_f32 v[190:191], v[190:191], v[186:187]
    s_waitcnt lgkmcnt(9)
    v_lshlrev_b32 v180, 16, v140
    v_and_b32 v181, s99, v140
    v_lshlrev_b32 v182, 16, v141
    v_and_b32 v183, s99, v141
    s_add_u32 m0, s10, 127296
    s_nop 0
    buffer_load_dwordx4 v32, s[52:55], s14 offen nt lds
    s_waitcnt lgkmcnt(8)
    v_lshlrev_b32 v184, 16, v156
    v_and_b32 v185, s99, v156
    v_lshlrev_b32 v186, 16, v157
    v_and_b32 v187, s99, v157
    v_pk_mul_f32 v[192:193], v[168:169], v[52:53]
    v_pk_mul_f32 v[194:195], v[170:171], v[54:55]
    v_pk_fma_f32 v[192:193], v[172:173], v[48:49], v[192:193]
    v_pk_fma_f32 v[194:195], v[174:175], v[50:51], v[194:195]
    v_pk_fma_f32 v[192:193], v[176:177], v[44:45], v[192:193]
    v_pk_fma_f32 v[194:195], v[178:179], v[46:47], v[194:195]
    v_pk_fma_f32 v[192:193], v[180:181], v[40:41], v[192:193]
    v_pk_fma_f32 v[194:195], v[182:183], v[42:43], v[194:195]
    v_pk_mul_f32 v[192:193], v[192:193], v[184:185]
    v_pk_mul_f32 v[194:195], v[194:195], v[186:187]
    v_cvt_pk_bf16_f32 v198, v192, v188
    v_cvt_pk_bf16_f32 v202, v193, v189
    v_cvt_pk_bf16_f32 v206, v194, v190
    v_cvt_pk_bf16_f32 v210, v195, v191
    s_add_u32 m0, s10, 58752
    s_add_u32 s14, s15, 409600
    buffer_load_dwordx4 v32, s[48:51], s14 offen nt lds
    s_waitcnt lgkmcnt(7)
    v_lshlrev_b32 v168, 16, v142
    v_and_b32 v169, s99, v142
    v_lshlrev_b32 v170, 16, v143
    v_and_b32 v171, s99, v143
    s_waitcnt lgkmcnt(6)
    v_lshlrev_b32 v184, 16, v158
    v_and_b32 v185, s99, v158
    v_lshlrev_b32 v186, 16, v159
    v_and_b32 v187, s99, v159
    v_pk_mul_f32 v[188:189], v[172:173], v[52:53]
    v_pk_mul_f32 v[190:191], v[174:175], v[54:55]
    v_pk_fma_f32 v[188:189], v[176:177], v[48:49], v[188:189]
    v_pk_fma_f32 v[190:191], v[178:179], v[50:51], v[190:191]
    v_pk_fma_f32 v[188:189], v[180:181], v[44:45], v[188:189]
    v_pk_fma_f32 v[190:191], v[182:183], v[46:47], v[190:191]
    v_pk_fma_f32 v[188:189], v[168:169], v[40:41], v[188:189]
    v_pk_fma_f32 v[190:191], v[170:171], v[42:43], v[190:191]
    v_pk_mul_f32 v[188:189], v[188:189], v[184:185]
    v_pk_mul_f32 v[190:191], v[190:191], v[186:187]
    s_add_u32 m0, s10, 128384
    s_nop 0
    buffer_load_dwordx4 v32, s[52:55], s14 offen nt lds
    s_waitcnt lgkmcnt(5)
    v_lshlrev_b32 v172, 16, v144
    v_and_b32 v173, s99, v144
    v_lshlrev_b32 v174, 16, v145
    v_and_b32 v175, s99, v145
    s_waitcnt lgkmcnt(4)
    v_lshlrev_b32 v184, 16, v160
    v_and_b32 v185, s99, v160
    v_lshlrev_b32 v186, 16, v161
    v_and_b32 v187, s99, v161
    v_pk_mul_f32 v[192:193], v[176:177], v[52:53]
    v_pk_mul_f32 v[194:195], v[178:179], v[54:55]
    v_pk_fma_f32 v[192:193], v[180:181], v[48:49], v[192:193]
    v_pk_fma_f32 v[194:195], v[182:183], v[50:51], v[194:195]
    v_pk_fma_f32 v[192:193], v[168:169], v[44:45], v[192:193]
    v_pk_fma_f32 v[194:195], v[170:171], v[46:47], v[194:195]
    v_pk_fma_f32 v[192:193], v[172:173], v[40:41], v[192:193]
    v_pk_fma_f32 v[194:195], v[174:175], v[42:43], v[194:195]
    v_pk_mul_f32 v[192:193], v[192:193], v[184:185]
    v_pk_mul_f32 v[194:195], v[194:195], v[186:187]
    s_add_u32 m0, s10, 59840
    s_add_u32 s14, s15, 417792
    buffer_load_dwordx4 v32, s[48:51], s14 offen nt lds
    v_cvt_pk_bf16_f32 v197, v192, v188
    v_cvt_pk_bf16_f32 v201, v193, v189
    v_cvt_pk_bf16_f32 v205, v194, v190
    v_cvt_pk_bf16_f32 v209, v195, v191
    s_waitcnt lgkmcnt(3)
    v_lshlrev_b32 v176, 16, v146
    v_and_b32 v177, s99, v146
    v_lshlrev_b32 v178, 16, v147
    v_and_b32 v179, s99, v147
    s_waitcnt lgkmcnt(2)
    v_lshlrev_b32 v184, 16, v162
    v_and_b32 v185, s99, v162
    v_lshlrev_b32 v186, 16, v163
    v_and_b32 v187, s99, v163
    v_pk_mul_f32 v[188:189], v[180:181], v[52:53]
    v_pk_mul_f32 v[190:191], v[182:183], v[54:55]
    v_pk_fma_f32 v[188:189], v[168:169], v[48:49], v[188:189]
    v_pk_fma_f32 v[190:191], v[170:171], v[50:51], v[190:191]
    v_pk_fma_f32 v[188:189], v[172:173], v[44:45], v[188:189]
    v_pk_fma_f32 v[190:191], v[174:175], v[46:47], v[190:191]
    s_add_u32 m0, s10, 129472
    s_nop 0
    buffer_load_dwordx4 v32, s[52:55], s14 offen nt lds
    v_pk_fma_f32 v[188:189], v[176:177], v[40:41], v[188:189]
    v_pk_fma_f32 v[190:191], v[178:179], v[42:43], v[190:191]
    v_pk_mul_f32 v[188:189], v[188:189], v[184:185]
    v_pk_mul_f32 v[190:191], v[190:191], v[186:187]
    s_waitcnt lgkmcnt(1)
    v_lshlrev_b32 v180, 16, v148
    v_and_b32 v181, s99, v148
    v_lshlrev_b32 v182, 16, v149
    v_and_b32 v183, s99, v149
    s_waitcnt lgkmcnt(0)
    v_lshlrev_b32 v184, 16, v164
    v_and_b32 v185, s99, v164
    v_lshlrev_b32 v186, 16, v165
    v_and_b32 v187, s99, v165
    v_pk_mul_f32 v[192:193], v[168:169], v[52:53]
    v_pk_mul_f32 v[194:195], v[170:171], v[54:55]
    v_pk_fma_f32 v[192:193], v[172:173], v[48:49], v[192:193]
    v_pk_fma_f32 v[194:195], v[174:175], v[50:51], v[194:195]
    v_pk_fma_f32 v[192:193], v[176:177], v[44:45], v[192:193]
    v_pk_fma_f32 v[194:195], v[178:179], v[46:47], v[194:195]
    v_pk_fma_f32 v[192:193], v[180:181], v[40:41], v[192:193]
    v_pk_fma_f32 v[194:195], v[182:183], v[42:43], v[194:195]
    v_pk_mul_f32 v[192:193], v[192:193], v[184:185]
    v_pk_mul_f32 v[194:195], v[194:195], v[186:187]
    v_cvt_pk_bf16_f32 v196, v192, v188
    v_cvt_pk_bf16_f32 v200, v193, v189
    v_cvt_pk_bf16_f32 v204, v194, v190
    v_cvt_pk_bf16_f32 v208, v195, v191
    s_add_u32 s7, s8, 1
    s_and_b32 s7, s7, 7
    s_lshl_b32 s7, s7, 18
    s_add_u32 s7, s7, s4
    s_add_u32 s6, s7, 256
    buffer_store_dwordx4 v[196:199], v36, s[56:59], s6 offen sc1
    s_add_u32 s6, s7, 4352
    buffer_store_dwordx4 v[200:203], v36, s[56:59], s6 offen sc1
    s_add_u32 s6, s7, 8448
    buffer_store_dwordx4 v[204:207], v36, s[56:59], s6 offen sc1
    s_add_u32 s6, s7, 12544
    buffer_store_dwordx4 v[208:211], v36, s[56:59], s6 offen sc1
    s_waitcnt vmcnt(12)
    v_cmp_ne_u32 vcc, 0, v26
    s_nop 0
    s_cmp_eq_u64 vcc, exec
    s_cbranch_scc1 L_nok_20
    s_mov_b32 s100, 0
    v_mov_b32 v28, 0
    L_nlp_21:
    global_load_dwordx2 v[26:27], v28, s[40:41] sc1
    s_waitcnt vmcnt(0)
    v_cmp_ne_u32 vcc, 0, v26
    s_add_u32 s100, s100, 1
    s_nop 1
    s_cmp_eq_u64 vcc, exec
    s_cbranch_scc1 L_nok_20
    s_sleep 4
    s_cmp_lt_u32 s100, 200000
    s_cbranch_scc1 L_nlp_21
L_nok_20:
    v_readfirstlane_b32 s72, v26
    v_readfirstlane_b32 s73, v27
    s_barrier
    ds_read_b64 v[128:129], v34 offset:37632
    ds_read_b64 v[130:131], v34 offset:37760
    ds_read_b64 v[132:133], v34 offset:37888
    ds_read_b64 v[134:135], v34 offset:38080
    ds_read_b64 v[150:151], v35 offset:34816
    ds_read_b64 v[136:137], v34 offset:38208
    ds_read_b64 v[152:153], v35 offset:34944
    ds_read_b64 v[138:139], v34 offset:38336
    ds_read_b64 v[154:155], v35 offset:35072
    ds_read_b64 v[140:141], v34 offset:38464
    ds_read_b64 v[156:157], v35 offset:35200
    ds_read_b64 v[142:143], v34 offset:38592
    ds_read_b64 v[158:159], v35 offset:35328
    ds_read_b64 v[144:145], v34 offset:38720
    ds_read_b64 v[160:161], v35 offset:35456
    s_waitcnt lgkmcnt(14)
    ds_read_b64 v[146:147], v34 offset:38848
    s_waitcnt lgkmcnt(14)
    ds_read_b64 v[162:163], v35 offset:35584
    s_waitcnt lgkmcnt(14)
    ds_read_b64 v[148:149], v34 offset:38976
    s_waitcnt lgkmcnt(14)
    ds_read_b64 v[164:165], v35 offset:35712
    v_lshlrev_b32 v40, 16, v72
    v_and_b32 v44, s99, v72
    v_lshlrev_b32 v48, 16, v73
    v_and_b32 v52, s99, v73
    v_lshlrev_b32 v41, 16, v74
    v_and_b32 v45, s99, v74
    v_lshlrev_b32 v49, 16, v75
    v_and_b32 v53, s99, v75
    v_lshlrev_b32 v42, 16, v76
    v_and_b32 v46, s99, v76
    v_lshlrev_b32 v50, 16, v77
    v_and_b32 v54, s99, v77
    v_lshlrev_b32 v43, 16, v78
    v_and_b32 v47, s99, v78
    v_lshlrev_b32 v51, 16, v79
    v_and_b32 v55, s99, v79
    v_lshlrev_b32 v172, 16, v128
    v_and_b32 v173, s99, v128
    v_lshlrev_b32 v174, 16, v129
    v_and_b32 v175, s99, v129
    v_lshlrev_b32 v176, 16, v130
    v_and_b32 v177, s99, v130
    v_lshlrev_b32 v178, 16, v131
    v_and_b32 v179, s99, v131
    v_lshlrev_b32 v180, 16, v132
    v_and_b32 v181, s99, v132
    v_lshlrev_b32 v182, 16, v133
    v_and_b32 v183, s99, v133
    v_lshlrev_b32 v168, 16, v134
    v_and_b32 v169, s99, v134
    v_lshlrev_b32 v170, 16, v135
    v_and_b32 v171, s99, v135
    s_waitcnt lgkmcnt(14)
    v_lshlrev_b32 v184, 16, v150
    v_and_b32 v185, s99, v150
    v_lshlrev_b32 v186, 16, v151
    v_and_b32 v187, s99, v151
    v_pk_mul_f32 v[188:189], v[172:173], v[52:53]
    v_pk_mul_f32 v[190:191], v[174:175], v[54:55]
    v_pk_fma_f32 v[188:189], v[176:177], v[48:49], v[188:189]
    v_pk_fma_f32 v[190:191], v[178:179], v[50:51], v[190:191]
    v_pk_fma_f32 v[188:189], v[180:181], v[44:45], v[188:189]
    v_pk_fma_f32 v[190:191], v[182:183], v[46:47], v[190:191]
    v_pk_fma_f32 v[188:189], v[168:169], v[40:41], v[188:189]
    v_pk_fma_f32 v[190:191], v[170:171], v[42:43], v[190:191]
    v_pk_mul_f32 v[188:189], v[188:189], v[184:185]
    v_pk_mul_f32 v[190:191], v[190:191], v[186:187]
    s_waitcnt lgkmcnt(13)
    v_lshlrev_b32 v172, 16, v136
    v_and_b32 v173, s99, v136
    v_lshlrev_b32 v174, 16, v137
    v_and_b32 v175, s99, v137
    s_waitcnt lgkmcnt(12)
    v_lshlrev_b32 v184, 16, v152
    v_and_b32 v185, s99, v152
    v_lshlrev_b32 v186, 16, v153
    v_and_b32 v187, s99, v153
    v_pk_mul_f32 v[192:193], v[176:177], v[52:53]
    v_pk_mul_f32 v[194:195], v[178:179], v[54:55]
    v_pk_fma_f32 v[192:193], v[180:181], v[48:49], v[192:193]
    v_pk_fma_f32 v[194:195], v[182:183], v[50:51], v[194:195]
    v_pk_fma_f32 v[192:193], v[168:169], v[44:45], v[192:193]
    v_pk_fma_f32 v[194:195], v[170:171], v[46:47], v[194:195]
    v_pk_fma_f32 v[192:193], v[172:173], v[40:41], v[192:193]
    v_pk_fma_f32 v[194:195], v[174:175], v[42:43], v[194:195]
    v_pk_mul_f32 v[192:193], v[192:193], v[184:185]
    v_pk_mul_f32 v[194:195], v[194:195], v[186:187]
    v_cvt_pk_bf16_f32 v199, v192, v188
    v_cvt_pk_bf16_f32 v203, v193, v189
    v_cvt_pk_bf16_f32 v207, v194, v190
    v_cvt_pk_bf16_f32 v211, v195, v191
    s_waitcnt lgkmcnt(11)
    v_lshlrev_b32 v176, 16, v138
    v_and_b32 v177, s99, v138
    v_lshlrev_b32 v178, 16, v139
    v_and_b32 v179, s99, v139
    s_waitcnt lgkmcnt(10)
    v_lshlrev_b32 v184, 16, v154
    v_and_b32 v185, s99, v154
    v_lshlrev_b32 v186, 16, v155
    v_and_b32 v187, s99, v155
    v_pk_mul_f32 v[188:189], v[180:181], v[52:53]
    v_pk_mul_f32 v[190:191], v[182:183], v[54:55]
    v_pk_fma_f32 v[188:189], v[168:169], v[48:49], v[188:189]
    v_pk_fma_f32 v[190:191], v[170:171], v[50:51], v[190:191]
    v_pk_fma_f32 v[188:189], v[172:173], v[44:45], v[188:189]
    v_pk_fma_f32 v[190:191], v[174:175], v[46:47], v[190:191]
    v_pk_fma_f32 v[188:189], v[176:177], v[40:41], v[188:189]
    v_pk_fma_f32 v[190:191], v[178:179], v[42:43], v[190:191]
    v_pk_mul_f32 v[188:189], v[188:189], v[184:185]
    v_pk_mul_f32 v[190:191], v[190:191], v[186:187]
    s_waitcnt lgkmcnt(9)
    v_lshlrev_b32 v180, 16, v140
    v_and_b32 v181, s99, v140
    v_lshlrev_b32 v182, 16, v141
    v_and_b32 v183, s99, v141
    s_waitcnt lgkmcnt(8)
    v_lshlrev_b32 v184, 16, v156
    v_and_b32 v185, s99, v156
    v_lshlrev_b32 v186, 16, v157
    v_and_b32 v187, s99, v157
    v_pk_mul_f32 v[192:193], v[168:169], v[52:53]
    v_pk_mul_f32 v[194:195], v[170:171], v[54:55]
    v_pk_fma_f32 v[192:193], v[172:173], v[48:49], v[192:193]
    v_pk_fma_f32 v[194:195], v[174:175], v[50:51], v[194:195]
    v_pk_fma_f32 v[192:193], v[176:177], v[44:45], v[192:193]
    v_pk_fma_f32 v[194:195], v[178:179], v[46:47], v[194:195]
    v_pk_fma_f32 v[192:193], v[180:181], v[40:41], v[192:193]
    v_pk_fma_f32 v[194:195], v[182:183], v[42:43], v[194:195]
    v_pk_mul_f32 v[192:193], v[192:193], v[184:185]
    v_pk_mul_f32 v[194:195], v[194:195], v[186:187]
    v_cvt_pk_bf16_f32 v198, v192, v188
    v_cvt_pk_bf16_f32 v202, v193, v189
    v_cvt_pk_bf16_f32 v206, v194, v190
    v_cvt_pk_bf16_f32 v210, v195, v191
    s_waitcnt lgkmcnt(7)
    v_lshlrev_b32 v168, 16, v142
    v_and_b32 v169, s99, v142
    v_lshlrev_b32 v170, 16, v143
    v_and_b32 v171, s99, v143
    s_waitcnt lgkmcnt(6)
    v_lshlrev_b32 v184, 16, v158
    v_and_b32 v185, s99, v158
    v_lshlrev_b32 v186, 16, v159
    v_and_b32 v187, s99, v159
    v_pk_mul_f32 v[188:189], v[172:173], v[52:53]
    v_pk_mul_f32 v[190:191], v[174:175], v[54:55]
    v_pk_fma_f32 v[188:189], v[176:177], v[48:49], v[188:189]
    v_pk_fma_f32 v[190:191], v[178:179], v[50:51], v[190:191]
    v_pk_fma_f32 v[188:189], v[180:181], v[44:45], v[188:189]
    v_pk_fma_f32 v[190:191], v[182:183], v[46:47], v[190:191]
    v_pk_fma_f32 v[188:189], v[168:169], v[40:41], v[188:189]
    v_pk_fma_f32 v[190:191], v[170:171], v[42:43], v[190:191]
    v_pk_mul_f32 v[188:189], v[188:189], v[184:185]
    v_pk_mul_f32 v[190:191], v[190:191], v[186:187]
    s_waitcnt lgkmcnt(5)
    v_lshlrev_b32 v172, 16, v144
    v_and_b32 v173, s99, v144
    v_lshlrev_b32 v174, 16, v145
    v_and_b32 v175, s99, v145
    s_waitcnt lgkmcnt(4)
    v_lshlrev_b32 v184, 16, v160
    v_and_b32 v185, s99, v160
    v_lshlrev_b32 v186, 16, v161
    v_and_b32 v187, s99, v161
    v_pk_mul_f32 v[192:193], v[176:177], v[52:53]
    v_pk_mul_f32 v[194:195], v[178:179], v[54:55]
    v_pk_fma_f32 v[192:193], v[180:181], v[48:49], v[192:193]
    v_pk_fma_f32 v[194:195], v[182:183], v[50:51], v[194:195]
    v_pk_fma_f32 v[192:193], v[168:169], v[44:45], v[192:193]
    v_pk_fma_f32 v[194:195], v[170:171], v[46:47], v[194:195]
    v_pk_fma_f32 v[192:193], v[172:173], v[40:41], v[192:193]
    v_pk_fma_f32 v[194:195], v[174:175], v[42:43], v[194:195]
    v_pk_mul_f32 v[192:193], v[192:193], v[184:185]
    v_pk_mul_f32 v[194:195], v[194:195], v[186:187]
    v_cvt_pk_bf16_f32 v197, v192, v188
    v_cvt_pk_bf16_f32 v201, v193, v189
    v_cvt_pk_bf16_f32 v205, v194, v190
    v_cvt_pk_bf16_f32 v209, v195, v191
    s_waitcnt lgkmcnt(3)
    v_lshlrev_b32 v176, 16, v146
    v_and_b32 v177, s99, v146
    v_lshlrev_b32 v178, 16, v147
    v_and_b32 v179, s99, v147
    s_waitcnt lgkmcnt(2)
    v_lshlrev_b32 v184, 16, v162
    v_and_b32 v185, s99, v162
    v_lshlrev_b32 v186, 16, v163
    v_and_b32 v187, s99, v163
    v_pk_mul_f32 v[188:189], v[180:181], v[52:53]
    v_pk_mul_f32 v[190:191], v[182:183], v[54:55]
    v_pk_fma_f32 v[188:189], v[168:169], v[48:49], v[188:189]
    v_pk_fma_f32 v[190:191], v[170:171], v[50:51], v[190:191]
    v_pk_fma_f32 v[188:189], v[172:173], v[44:45], v[188:189]
    v_pk_fma_f32 v[190:191], v[174:175], v[46:47], v[190:191]
    v_pk_fma_f32 v[188:189], v[176:177], v[40:41], v[188:189]
    v_pk_fma_f32 v[190:191], v[178:179], v[42:43], v[190:191]
    v_pk_mul_f32 v[188:189], v[188:189], v[184:185]
    v_pk_mul_f32 v[190:191], v[190:191], v[186:187]
    s_waitcnt lgkmcnt(1)
    v_lshlrev_b32 v180, 16, v148
    v_and_b32 v181, s99, v148
    v_lshlrev_b32 v182, 16, v149
    v_and_b32 v183, s99, v149
    s_waitcnt lgkmcnt(0)
    v_lshlrev_b32 v184, 16, v164
    v_and_b32 v185, s99, v164
    v_lshlrev_b32 v186, 16, v165
    v_and_b32 v187, s99, v165
    v_pk_mul_f32 v[192:193], v[168:169], v[52:53]
    v_pk_mul_f32 v[194:195], v[170:171], v[54:55]
    v_pk_fma_f32 v[192:193], v[172:173], v[48:49], v[192:193]
    v_pk_fma_f32 v[194:195], v[174:175], v[50:51], v[194:195]
    v_pk_fma_f32 v[192:193], v[176:177], v[44:45], v[192:193]
    v_pk_fma_f32 v[194:195], v[178:179], v[46:47], v[194:195]
    v_pk_fma_f32 v[192:193], v[180:181], v[40:41], v[192:193]
    v_pk_fma_f32 v[194:195], v[182:183], v[42:43], v[194:195]
    v_pk_mul_f32 v[192:193], v[192:193], v[184:185]
    v_pk_mul_f32 v[194:195], v[194:195], v[186:187]
    v_cvt_pk_bf16_f32 v196, v192, v188
    v_cvt_pk_bf16_f32 v200, v193, v189
    v_cvt_pk_bf16_f32 v204, v194, v190
    v_cvt_pk_bf16_f32 v208, v195, v191
    s_add_u32 s7, s8, 2
    s_and_b32 s7, s7, 7
    s_lshl_b32 s7, s7, 18
    s_add_u32 s7, s7, s4
    s_add_u32 s6, s7, 512
    buffer_store_dwordx4 v[196:199], v36, s[56:59], s6 offen sc1
    s_add_u32 s6, s7, 4608
    buffer_store_dwordx4 v[200:203], v36, s[56:59], s6 offen sc1
    s_add_u32 s6, s7, 8704
    buffer_store_dwordx4 v[204:207], v36, s[56:59], s6 offen sc1
    s_add_u32 s6, s7, 12800
    buffer_store_dwordx4 v[208:211], v36, s[56:59], s6 offen sc1
    s_waitcnt vmcnt(8)
    s_barrier
    ds_read_b64 v[128:129], v34 offset:56128
    ds_read_b64 v[130:131], v34 offset:56256
    ds_read_b64 v[132:133], v34 offset:56384
    ds_read_b64 v[134:135], v34 offset:56576
    ds_read_b64 v[150:151], v35 offset:52224
    ds_read_b64 v[136:137], v34 offset:56704
    ds_read_b64 v[152:153], v35 offset:52352
    ds_read_b64 v[138:139], v34 offset:56832
    ds_read_b64 v[154:155], v35 offset:52480
    ds_read_b64 v[140:141], v34 offset:56960
    ds_read_b64 v[156:157], v35 offset:52608
    ds_read_b64 v[142:143], v34 offset:57088
    ds_read_b64 v[158:159], v35 offset:52736
    ds_read_b64 v[144:145], v34 offset:57216
    ds_read_b64 v[160:161], v35 offset:52864
    s_waitcnt lgkmcnt(14)
    ds_read_b64 v[146:147], v34 offset:57344
    s_waitcnt lgkmcnt(14)
    ds_read_b64 v[162:163], v35 offset:52992
    s_waitcnt lgkmcnt(14)
    ds_read_b64 v[148:149], v34 offset:57472
    s_waitcnt lgkmcnt(14)
    ds_read_b64 v[164:165], v35 offset:53120
    v_lshlrev_b32 v40, 16, v80
    v_and_b32 v44, s99, v80
    v_lshlrev_b32 v48, 16, v81
    v_and_b32 v52, s99, v81
    v_lshlrev_b32 v41, 16, v82
    v_and_b32 v45, s99, v82
    v_lshlrev_b32 v49, 16, v83
    v_and_b32 v53, s99, v83
    v_lshlrev_b32 v42, 16, v84
    v_and_b32 v46, s99, v84
    v_lshlrev_b32 v50, 16, v85
    v_and_b32 v54, s99, v85
    v_lshlrev_b32 v43, 16, v86
    v_and_b32 v47, s99, v86
    v_lshlrev_b32 v51, 16, v87
    v_and_b32 v55, s99, v87
    v_lshlrev_b32 v172, 16, v128
    v_and_b32 v173, s99, v128
    v_lshlrev_b32 v174, 16, v129
    v_and_b32 v175, s99, v129
    v_lshlrev_b32 v176, 16, v130
    v_and_b32 v177, s99, v130
    v_lshlrev_b32 v178, 16, v131
    v_and_b32 v179, s99, v131
    v_lshlrev_b32 v180, 16, v132
    v_and_b32 v181, s99, v132
    v_lshlrev_b32 v182, 16, v133
    v_and_b32 v183, s99, v133
    v_lshlrev_b32 v168, 16, v134
    v_and_b32 v169, s99, v134
    v_lshlrev_b32 v170, 16, v135
    v_and_b32 v171, s99, v135
    s_waitcnt lgkmcnt(14)
    v_lshlrev_b32 v184, 16, v150
    v_and_b32 v185, s99, v150
    v_lshlrev_b32 v186, 16, v151
    v_and_b32 v187, s99, v151
    v_pk_mul_f32 v[188:189], v[172:173], v[52:53]
    v_pk_mul_f32 v[190:191], v[174:175], v[54:55]
    v_pk_fma_f32 v[188:189], v[176:177], v[48:49], v[188:189]
    v_pk_fma_f32 v[190:191], v[178:179], v[50:51], v[190:191]
    v_pk_fma_f32 v[188:189], v[180:181], v[44:45], v[188:189]
    v_pk_fma_f32 v[190:191], v[182:183], v[46:47], v[190:191]
    v_pk_fma_f32 v[188:189], v[168:169], v[40:41], v[188:189]
    v_pk_fma_f32 v[190:191], v[170:171], v[42:43], v[190:191]
    v_pk_mul_f32 v[188:189], v[188:189], v[184:185]
    v_pk_mul_f32 v[190:191], v[190:191], v[186:187]
    s_waitcnt lgkmcnt(13)
    v_lshlrev_b32 v172, 16, v136
    v_and_b32 v173, s99, v136
    v_lshlrev_b32 v174, 16, v137
    v_and_b32 v175, s99, v137
    s_waitcnt lgkmcnt(12)
    v_lshlrev_b32 v184, 16, v152
    v_and_b32 v185, s99, v152
    v_lshlrev_b32 v186, 16, v153
    v_and_b32 v187, s99, v153
    v_pk_mul_f32 v[192:193], v[176:177], v[52:53]
    v_pk_mul_f32 v[194:195], v[178:179], v[54:55]
    v_pk_fma_f32 v[192:193], v[180:181], v[48:49], v[192:193]
    v_pk_fma_f32 v[194:195], v[182:183], v[50:51], v[194:195]
    v_pk_fma_f32 v[192:193], v[168:169], v[44:45], v[192:193]
    v_pk_fma_f32 v[194:195], v[170:171], v[46:47], v[194:195]
    v_pk_fma_f32 v[192:193], v[172:173], v[40:41], v[192:193]
    v_pk_fma_f32 v[194:195], v[174:175], v[42:43], v[194:195]
    v_pk_mul_f32 v[192:193], v[192:193], v[184:185]
    v_pk_mul_f32 v[194:195], v[194:195], v[186:187]
    v_cvt_pk_bf16_f32 v199, v192, v188
    v_cvt_pk_bf16_f32 v203, v193, v189
    v_cvt_pk_bf16_f32 v207, v194, v190
    v_cvt_pk_bf16_f32 v211, v195, v191
    s_waitcnt lgkmcnt(11)
    v_lshlrev_b32 v176, 16, v138
    v_and_b32 v177, s99, v138
    v_lshlrev_b32 v178, 16, v139
    v_and_b32 v179, s99, v139
    s_waitcnt lgkmcnt(10)
    v_lshlrev_b32 v184, 16, v154
    v_and_b32 v185, s99, v154
    v_lshlrev_b32 v186, 16, v155
    v_and_b32 v187, s99, v155
    v_pk_mul_f32 v[188:189], v[180:181], v[52:53]
    v_pk_mul_f32 v[190:191], v[182:183], v[54:55]
    v_pk_fma_f32 v[188:189], v[168:169], v[48:49], v[188:189]
    v_pk_fma_f32 v[190:191], v[170:171], v[50:51], v[190:191]
    v_pk_fma_f32 v[188:189], v[172:173], v[44:45], v[188:189]
    v_pk_fma_f32 v[190:191], v[174:175], v[46:47], v[190:191]
    v_pk_fma_f32 v[188:189], v[176:177], v[40:41], v[188:189]
    v_pk_fma_f32 v[190:191], v[178:179], v[42:43], v[190:191]
    v_pk_mul_f32 v[188:189], v[188:189], v[184:185]
    v_pk_mul_f32 v[190:191], v[190:191], v[186:187]
    s_waitcnt lgkmcnt(9)
    v_lshlrev_b32 v180, 16, v140
    v_and_b32 v181, s99, v140
    v_lshlrev_b32 v182, 16, v141
    v_and_b32 v183, s99, v141
    s_waitcnt lgkmcnt(8)
    v_lshlrev_b32 v184, 16, v156
    v_and_b32 v185, s99, v156
    v_lshlrev_b32 v186, 16, v157
    v_and_b32 v187, s99, v157
    v_pk_mul_f32 v[192:193], v[168:169], v[52:53]
    v_pk_mul_f32 v[194:195], v[170:171], v[54:55]
    v_pk_fma_f32 v[192:193], v[172:173], v[48:49], v[192:193]
    v_pk_fma_f32 v[194:195], v[174:175], v[50:51], v[194:195]
    v_pk_fma_f32 v[192:193], v[176:177], v[44:45], v[192:193]
    v_pk_fma_f32 v[194:195], v[178:179], v[46:47], v[194:195]
    v_pk_fma_f32 v[192:193], v[180:181], v[40:41], v[192:193]
    v_pk_fma_f32 v[194:195], v[182:183], v[42:43], v[194:195]
    v_pk_mul_f32 v[192:193], v[192:193], v[184:185]
    v_pk_mul_f32 v[194:195], v[194:195], v[186:187]
    v_cvt_pk_bf16_f32 v198, v192, v188
    v_cvt_pk_bf16_f32 v202, v193, v189
    v_cvt_pk_bf16_f32 v206, v194, v190
    v_cvt_pk_bf16_f32 v210, v195, v191
    s_waitcnt lgkmcnt(7)
    v_lshlrev_b32 v168, 16, v142
    v_and_b32 v169, s99, v142
    v_lshlrev_b32 v170, 16, v143
    v_and_b32 v171, s99, v143
    s_waitcnt lgkmcnt(6)
    v_lshlrev_b32 v184, 16, v158
    v_and_b32 v185, s99, v158
    v_lshlrev_b32 v186, 16, v159
    v_and_b32 v187, s99, v159
    v_pk_mul_f32 v[188:189], v[172:173], v[52:53]
    v_pk_mul_f32 v[190:191], v[174:175], v[54:55]
    v_pk_fma_f32 v[188:189], v[176:177], v[48:49], v[188:189]
    v_pk_fma_f32 v[190:191], v[178:179], v[50:51], v[190:191]
    v_pk_fma_f32 v[188:189], v[180:181], v[44:45], v[188:189]
    v_pk_fma_f32 v[190:191], v[182:183], v[46:47], v[190:191]
    v_pk_fma_f32 v[188:189], v[168:169], v[40:41], v[188:189]
    v_pk_fma_f32 v[190:191], v[170:171], v[42:43], v[190:191]
    v_pk_mul_f32 v[188:189], v[188:189], v[184:185]
    v_pk_mul_f32 v[190:191], v[190:191], v[186:187]
    s_waitcnt lgkmcnt(5)
    v_lshlrev_b32 v172, 16, v144
    v_and_b32 v173, s99, v144
    v_lshlrev_b32 v174, 16, v145
    v_and_b32 v175, s99, v145
    s_waitcnt lgkmcnt(4)
    v_lshlrev_b32 v184, 16, v160
    v_and_b32 v185, s99, v160
    v_lshlrev_b32 v186, 16, v161
    v_and_b32 v187, s99, v161
    v_pk_mul_f32 v[192:193], v[176:177], v[52:53]
    v_pk_mul_f32 v[194:195], v[178:179], v[54:55]
    v_pk_fma_f32 v[192:193], v[180:181], v[48:49], v[192:193]
    v_pk_fma_f32 v[194:195], v[182:183], v[50:51], v[194:195]
    v_pk_fma_f32 v[192:193], v[168:169], v[44:45], v[192:193]
    v_pk_fma_f32 v[194:195], v[170:171], v[46:47], v[194:195]
    v_pk_fma_f32 v[192:193], v[172:173], v[40:41], v[192:193]
    v_pk_fma_f32 v[194:195], v[174:175], v[42:43], v[194:195]
    v_pk_mul_f32 v[192:193], v[192:193], v[184:185]
    v_pk_mul_f32 v[194:195], v[194:195], v[186:187]
    v_cvt_pk_bf16_f32 v197, v192, v188
    v_cvt_pk_bf16_f32 v201, v193, v189
    v_cvt_pk_bf16_f32 v205, v194, v190
    v_cvt_pk_bf16_f32 v209, v195, v191
    s_waitcnt lgkmcnt(3)
    v_lshlrev_b32 v176, 16, v146
    v_and_b32 v177, s99, v146
    v_lshlrev_b32 v178, 16, v147
    v_and_b32 v179, s99, v147
    s_waitcnt lgkmcnt(2)
    v_lshlrev_b32 v184, 16, v162
    v_and_b32 v185, s99, v162
    v_lshlrev_b32 v186, 16, v163
    v_and_b32 v187, s99, v163
    v_pk_mul_f32 v[188:189], v[180:181], v[52:53]
    v_pk_mul_f32 v[190:191], v[182:183], v[54:55]
    v_pk_fma_f32 v[188:189], v[168:169], v[48:49], v[188:189]
    v_pk_fma_f32 v[190:191], v[170:171], v[50:51], v[190:191]
    v_pk_fma_f32 v[188:189], v[172:173], v[44:45], v[188:189]
    v_pk_fma_f32 v[190:191], v[174:175], v[46:47], v[190:191]
    v_pk_fma_f32 v[188:189], v[176:177], v[40:41], v[188:189]
    v_pk_fma_f32 v[190:191], v[178:179], v[42:43], v[190:191]
    v_pk_mul_f32 v[188:189], v[188:189], v[184:185]
    v_pk_mul_f32 v[190:191], v[190:191], v[186:187]
    s_waitcnt lgkmcnt(1)
    v_lshlrev_b32 v180, 16, v148
    v_and_b32 v181, s99, v148
    v_lshlrev_b32 v182, 16, v149
    v_and_b32 v183, s99, v149
    s_waitcnt lgkmcnt(0)
    v_lshlrev_b32 v184, 16, v164
    v_and_b32 v185, s99, v164
    v_lshlrev_b32 v186, 16, v165
    v_and_b32 v187, s99, v165
    v_pk_mul_f32 v[192:193], v[168:169], v[52:53]
    v_pk_mul_f32 v[194:195], v[170:171], v[54:55]
    v_pk_fma_f32 v[192:193], v[172:173], v[48:49], v[192:193]
    v_pk_fma_f32 v[194:195], v[174:175], v[50:51], v[194:195]
    v_pk_fma_f32 v[192:193], v[176:177], v[44:45], v[192:193]
    v_pk_fma_f32 v[194:195], v[178:179], v[46:47], v[194:195]
    v_pk_fma_f32 v[192:193], v[180:181], v[40:41], v[192:193]
    v_pk_fma_f32 v[194:195], v[182:183], v[42:43], v[194:195]
    v_pk_mul_f32 v[192:193], v[192:193], v[184:185]
    v_pk_mul_f32 v[194:195], v[194:195], v[186:187]
    v_cvt_pk_bf16_f32 v196, v192, v188
    v_cvt_pk_bf16_f32 v200, v193, v189
    v_cvt_pk_bf16_f32 v204, v194, v190
    v_cvt_pk_bf16_f32 v208, v195, v191
    s_add_u32 s7, s8, 3
    s_and_b32 s7, s7, 7
    s_lshl_b32 s7, s7, 18
    s_add_u32 s7, s7, s4
    s_add_u32 s6, s7, 768
    buffer_store_dwordx4 v[196:199], v36, s[56:59], s6 offen sc1
    s_add_u32 s6, s7, 4864
    buffer_store_dwordx4 v[200:203], v36, s[56:59], s6 offen sc1
    s_add_u32 s6, s7, 8960
    buffer_store_dwordx4 v[204:207], v36, s[56:59], s6 offen sc1
    s_add_u32 s6, s7, 13056
    buffer_store_dwordx4 v[208:211], v36, s[56:59], s6 offen sc1
    s_lshl_b32 s13, s2, 7
    s_add_u32 s13, s13, 14024704
    s_lshr_b32 s5, s2, 5
    s_mul_i32 s5, s5, 3
    s_and_b32 s5, s5, 7
    s_cmp_lt_u32 s5, 2
    s_cselect_b32 s5, 0, 0
    s_xor_b32 s89, s2, s5
    s_mov_b64 s[56:57], s[42:43]
    s_mov_b32 s58, 14680064
    s_mov_b32 s59, 0x20000
    s_lshr_b32 s5, s88, 1
    s_lshl_b32 s6, s89, 1
    s_add_u32 s5, s5, s6
    s_lshl_b32 s6, s5, 12
    s_add_u32 s64, s24, s6
    s_addc_u32 s65, s25, 0
    s_mov_b32 s66, 4096
    s_mov_b32 s67, 0x20000
    s_lshl_b32 s6, s89, 2
    v_mov_b32 v28, s6
    global_load_dword v19, v28, s[26:27]
    s_and_b32 s6, s88, 1
    s_mul_i32 s6, s6, 2048
    s_sub_u32 s6, s6, 128
    v_add_u32 v30, s6, v1
    v_add_u32 v31, 16, v30
    v_add_u32 v29, 1024, v30
    v_cmp_gt_i32 vcc, 0, v30
    v_bfrev_b32 v28, 1
    s_nop 0
    v_cndmask_b32 v30, v30, v28, vcc
    v_cmp_gt_i32 vcc, 0, v31
    s_nop 1
    v_cndmask_b32 v31, v31, v28, vcc
    buffer_load_dwordx4 v[80:83], v30, s[64:67], 0 offen nt
    buffer_load_dwordx2 v[84:85], v31, s[64:67], 0 offen nt
    buffer_load_dwordx4 v[86:89], v29, s[64:67], 0 offen nt
    buffer_load_dwordx2 v[90:91], v29, s[64:67], 0 offen offset:16 nt
    buffer_load_dwordx4 v[92:95], v29, s[64:67], 0 offen offset:1024 nt
    buffer_load_dwordx2 v[96:97], v29, s[64:67], 0 offen offset:1040 nt
    s_mov_b32 s7, 0
    s_mul_i32 s8, s98, 7
    s_add_u32 s8, s8, 2
    s_lshr_b32 s7, s8, 2
    s_and_b32 s8, s2, 7
    s_mul_i32 s8, s8, 7
    s_lshr_b32 s8, s8, 2
    s_add_u32 s7, s7, s8
    s_sub_u32 s8, s7, 14
    s_cmp_ge_u32 s7, 14
    s_cselect_b32 s7, s8, s7
    s_mul_i32 s8, s88, 57344
    s_lshl_b32 s7, s7, 12
    s_add_u32 s9, s8, 57344
    s_add_u32 s74, s7, s8
    s_add_u32 s75, s74, 4096
    s_cmp_eq_u32 s75, s9
    s_cselect_b32 s75, s8, s75
    s_add_u32 s76, s75, 4096
    s_cmp_eq_u32 s76, s9
    s_cselect_b32 s76, s8, s76
    s_add_u32 s77, s76, 4096
    s_cmp_eq_u32 s77, s9
    s_cselect_b32 s77, s8, s77
    s_add_u32 s78, s77, 4096
    s_cmp_eq_u32 s78, s9
    s_cselect_b32 s78, s8, s78
    s_add_u32 s79, s78, 4096
    s_cmp_eq_u32 s79, s9
    s_cselect_b32 s79, s8, s79
    s_add_u32 s80, s79, 4096
    s_cmp_eq_u32 s80, s9
    s_cselect_b32 s80, s8, s80
    s_add_u32 s81, s80, 4096
    s_cmp_eq_u32 s81, s9
    s_cselect_b32 s81, s8, s81
    s_add_u32 s82, s81, 4096
    s_cmp_eq_u32 s82, s9
    s_cselect_b32 s82, s8, s82
    s_add_u32 s83, s82, 4096
    s_cmp_eq_u32 s83, s9
    s_cselect_b32 s83, s8, s83
    s_add_u32 s84, s83, 4096
    s_cmp_eq_u32 s84, s9
    s_cselect_b32 s84, s8, s84
    s_add_u32 s85, s84, 4096
    s_cmp_eq_u32 s85, s9
    s_cselect_b32 s85, s8, s85
    s_add_u32 s86, s85, 4096
    s_cmp_eq_u32 s86, s9
    s_cselect_b32 s86, s8, s86
    s_add_u32 s87, s86, 4096
    s_cmp_eq_u32 s87, s9
    s_cselect_b32 s87, s8, s87
    s_waitcnt vmcnt(7)
    s_barrier
    s_cmp_lg_u32 s88, 0
    s_cbranch_scc1 L_kf_22
    v_mov_b32 v28, 0
    s_mov_b64 exec, 1
    buffer_store_dwordx2 v[26:27], v28, s[56:59], s13 offen sc1
    s_mov_b64 exec, -1
    L_kf_22:
    s_waitcnt vmcnt(6)
    v_readfirstlane_b32 s101, v19
    s_lshr_b32 s7, s88, 1
    s_lshl_b32 s7, s7, 4
    s_lshr_b32 s101, s101, s7
    s_lshl_b32 s101, s101, 16
    s_lshl_b32 s6, s88, 14
    s_add_u32 s6, s6, 32768
    v_and_b32 v30, 3, v0
    v_mul_u32_u24 v30, 2368, v30
    v_and_b32 v31, 28, v0
    v_lshl_add_u32 v30, v31, 1, v30
    v_lshrrev_b32 v31, 5, v0
    v_lshlrev_b32 v31, 4, v31
    v_sub_u32 v30, v30, v31
    s_add_u32 s7, s6, 16
    v_add_u32 v18, s7, v30
    v_and_b32 v30, 31, v0
    v_mul_u32_u24 v30, 144, v30
    s_add_u32 s7, s6, 9280
    v_add3_u32 v19, v30, v31, s7
    s_mov_b64 s[68:69], s[34:35]
    s_mov_b32 s70, 1835008
    s_mov_b32 s71, 0x20000
    v_lshrrev_b32 v28, 3, v0
    v_bfe_u32 v29, v0, 4, 1
    v_lshlrev_b32 v29, 2, v29
    v_and_b32 v30, 7, v0
    v_xor_b32 v29, v29, v30
    v_lshlrev_b32 v28, 10, v28
    v_lshl_add_u32 v28, v29, 4, v28
    s_lshl_b32 s5, s98, 7
    v_add_u32 v22, s5, v28
    s_lshl_b32 s5, s88, 13
    s_add_u32 s29, s5, 98304
    v_lshrrev_b32 v28, 5, v0
    v_bfe_u32 v29, v0, 2, 2
    v_lshl_or_b32 v28, v28, 2, v29
    v_lshlrev_b32 v28, 7, v28
    v_add_u32 v28, s29, v28
    v_and_b32 v29, 1, v0
    v_lshl_add_u32 v28, v29, 3, v28
    v_bfe_u32 v29, v0, 4, 1
    v_bfe_u32 v30, v0, 1, 1
    v_lshl_or_b32 v29, v29, 1, v30
    v_bfe_u32 v30, v0, 3, 1
    v_lshl_or_b32 v29, v30, 2, v29
    s_and_b32 s5, s88, 1
    s_lshl_b32 s5, s5, 2
    s_and_b32 s6, s88, 2
    s_or_b32 s5, s5, s6
    v_xor_b32 v29, s5, v29
    v_lshl_add_u32 v20, v29, 4, v28
    v_xor_b32 v29, 4, v29
    v_lshl_add_u32 v21, v29, 4, v28
    s_lshl_b32 s96, s74, 3
    s_add_u32 m0, s29, 32768
    s_nop 0
    buffer_load_dwordx4 v22, s[68:71], s96 offen offset:0  lds
    s_add_u32 s96, s96, 7168
    buffer_load_dwordx4 v22, s[68:71], s96 offen offset:1024  lds
    s_add_u32 s96, s96, 9216
    s_add_u32 m0, s29, 34816
    s_nop 0
    buffer_load_dwordx4 v22, s[68:71], s96 offen offset:0  lds
    s_add_u32 s96, s96, 7168
    buffer_load_dwordx4 v22, s[68:71], s96 offen offset:1024  lds
    s_lshl_b32 s96, s75, 3
    s_add_u32 m0, s29, 0
    s_nop 0
    buffer_load_dwordx4 v22, s[68:71], s96 offen offset:0  lds
    s_add_u32 s96, s96, 7168
    buffer_load_dwordx4 v22, s[68:71], s96 offen offset:1024  lds
    s_add_u32 s96, s96, 9216
    s_add_u32 m0, s29, 2048
    s_nop 0
    buffer_load_dwordx4 v22, s[68:71], s96 offen offset:0  lds
    s_add_u32 s96, s96, 7168
    buffer_load_dwordx4 v22, s[68:71], s96 offen offset:1024  lds
    s_lshr_b32 s14, s89, 5
    v_and_b32 v23, 3, v0
    v_sub_u32 v23, s14, v23
    v_and_b32 v23, 7, v23
    v_lshlrev_b32 v23, 7, v23
    s_lshl_b32 s14, s88, 10
    s_add_u32 s14, s14, 14024704
    buffer_load_dwordx2 v[24:25], v23, s[56:59], s14 offen sc1
    s_lshl_b32 s96, s76, 3
    s_add_u32 m0, s29, 4096
    s_nop 0
    buffer_load_dwordx4 v22, s[68:71], s96 offen offset:0  lds
    s_add_u32 s96, s96, 7168
    buffer_load_dwordx4 v22, s[68:71], s96 offen offset:1024  lds
    s_add_u32 s96, s96, 9216
    s_add_u32 m0, s29, 6144
    s_nop 0
    buffer_load_dwordx4 v22, s[68:71], s96 offen offset:0  lds
    s_add_u32 s96, s96, 7168
    buffer_load_dwordx4 v22, s[68:71], s96 offen offset:1024  lds
    s_lshl_b32 s96, s77, 3
    s_sub_u32 m0, s29, 98304
    s_nop 0
    buffer_load_dwordx4 v22, s[68:71], s96 offen offset:0  lds
    s_add_u32 s96, s96, 7168
    buffer_load_dwordx4 v22, s[68:71], s96 offen offset:1024  lds
    s_add_u32 s96, s96, 9216
    s_sub_u32 m0, s29, 96256
    s_nop 0
    buffer_load_dwordx4 v22, s[68:71], s96 offen offset:0  lds
    s_add_u32 s96, s96, 7168
    buffer_load_dwordx4 v22, s[68:71], s96 offen offset:1024  lds
    s_lshl_b32 s96, s78, 3
    s_sub_u32 m0, s29, 94208
    s_nop 0
    buffer_load_dwordx4 v22, s[68:71], s96 offen offset:0  lds
    s_add_u32 s96, s96, 7168
    buffer_load_dwordx4 v22, s[68:71], s96 offen offset:1024  lds
    s_add_u32 s96, s96, 9216
    s_sub_u32 m0, s29, 92160
    s_nop 0
    buffer_load_dwordx4 v22, s[68:71], s96 offen offset:0  lds
    s_add_u32 s96, s96, 7168
    buffer_load_dwordx4 v22, s[68:71], s96 offen offset:1024  lds
    s_lshl_b32 s96, s79, 3
    s_add_u32 m0, s29, 36864
    s_nop 0
    buffer_load_dwordx4 v22, s[68:71], s96 offen offset:0  lds
    s_add_u32 s96, s96, 7168
    buffer_load_dwordx4 v22, s[68:71], s96 offen offset:1024  lds
    s_add_u32 s96, s96, 9216
    s_add_u32 m0, s29, 38912
    s_nop 0
    buffer_load_dwordx4 v22, s[68:71], s96 offen offset:0  lds
    s_add_u32 s96, s96, 7168
    buffer_load_dwordx4 v22, s[68:71], s96 offen offset:1024  lds
    s_lshl_b32 s6, s88, 14
    s_add_u32 s6, s6, 42048
    v_add_u32 v110, s6, v1
    v_mov_b32 v98, 0
    v_mov_b32 v99, 0
    v_mov_b32 v100, 0
    v_mov_b32 v101, 0
    ds_write_b128 v110, v[98:101] offset:0
    ds_write_b128 v110, v[98:101] offset:1024
    ds_write_b128 v110, v[98:101] offset:2048
    ds_write_b128 v110, v[98:101] offset:3072
    ds_write_b128 v110, v[98:101] offset:4096
    s_lshl_b32 s6, s88, 14
    s_add_u32 s6, s6, 32768
    v_add_u32 v111, s6, v1
    s_waitcnt vmcnt(30)
    v_alignbyte_b32 v98, v81, v80, 2
    v_alignbyte_b32 v99, v82, v81, 2
    v_alignbyte_b32 v100, v83, v82, 2
    s_waitcnt vmcnt(29)
    v_alignbyte_b32 v101, v84, v83, 2
    v_mov_b32 v102, v81
    v_mov_b32 v103, v82
    v_mov_b32 v104, v83
    v_mov_b32 v105, v84
    v_alignbyte_b32 v106, v82, v81, 2
    v_alignbyte_b32 v107, v83, v82, 2
    v_alignbyte_b32 v108, v84, v83, 2
    v_alignbyte_b32 v109, v85, v84, 2
    ds_write_b128 v111, v[98:101] offset:0
    ds_write_b128 v111, v[102:105] offset:2368
    ds_write_b128 v111, v[106:109] offset:4736
    ds_write_b128 v111, v[82:85] offset:7104
    s_waitcnt vmcnt(28)
    v_alignbyte_b32 v98, v87, v86, 2
    v_alignbyte_b32 v99, v88, v87, 2
    v_alignbyte_b32 v100, v89, v88, 2
    s_waitcnt vmcnt(27)
    v_alignbyte_b32 v101, v90, v89, 2
    v_mov_b32 v102, v87
    v_mov_b32 v103, v88
    v_mov_b32 v104, v89
    v_mov_b32 v105, v90
    v_alignbyte_b32 v106, v88, v87, 2
    v_alignbyte_b32 v107, v89, v88, 2
    v_alignbyte_b32 v108, v90, v89, 2
    v_alignbyte_b32 v109, v91, v90, 2
    ds_write_b128 v111, v[98:101] offset:1024
    ds_write_b128 v111, v[102:105] offset:3392
    ds_write_b128 v111, v[106:109] offset:5760
    ds_write_b128 v111, v[88:91] offset:8128
    s_waitcnt vmcnt(26)
    v_alignbyte_b32 v98, v93, v92, 2
    v_alignbyte_b32 v99, v94, v93, 2
    v_alignbyte_b32 v100, v95, v94, 2
    s_waitcnt vmcnt(25)
    v_alignbyte_b32 v101, v96, v95, 2
    v_mov_b32 v102, v93
    v_mov_b32 v103, v94
    v_mov_b32 v104, v95
    v_mov_b32 v105, v96
    v_alignbyte_b32 v106, v94, v93, 2
    v_alignbyte_b32 v107, v95, v94, 2
    v_alignbyte_b32 v108, v96, v95, 2
    v_alignbyte_b32 v109, v97, v96, 2
    s_mov_b64 exec, 0xff
    ds_write_b128 v111, v[98:101] offset:2048
    ds_write_b128 v111, v[102:105] offset:4416
    s_waitcnt lgkmcnt(14)
    ds_write_b128 v111, v[106:109] offset:6784
    s_waitcnt lgkmcnt(14)
    ds_write_b128 v111, v[94:97] offset:9152
    s_mov_b64 exec, -1
    s_waitcnt vmcnt(16)
    v_cmp_eq_u64 vcc, s[72:73], v[24:25]
    s_nop 0
    s_cmp_eq_u64 vcc, exec
    s_cbranch_scc1 L_ok_23
    s_mov_b32 s100, 0
    L_lp_24:
    buffer_load_dwordx2 v[24:25], v23, s[56:59], s14 offen sc1
    s_waitcnt vmcnt(0)
    v_cmp_eq_u64 vcc, s[72:73], v[24:25]
    s_add_u32 s100, s100, 1
    s_nop 1
    s_cmp_eq_u64 vcc, exec
    s_cbranch_scc1 L_ok_23
    s_sleep 4
    s_cmp_lt_u32 s100, 200000
    s_cbranch_scc1 L_lp_24
L_ok_23:
    s_barrier
    s_lshr_b32 s5, s88, 1
    s_lshl_b32 s6, s89, 1
    s_add_u32 s5, s5, s6
    s_lshl_b32 s5, s5, 12
    s_add_u32 s5, s5, 9437184
    buffer_load_dwordx4 v[112:115], v1, s[56:59], s5 offen offset:0 sc1
    buffer_load_dwordx4 v[116:119], v1, s[56:59], s5 offen offset:1024 sc1
    buffer_load_dwordx4 v[120:123], v1, s[56:59], s5 offen offset:2048 sc1
    buffer_load_dwordx4 v[124:127], v1, s[56:59], s5 offen offset:3072 sc1
    s_lshl_b32 s5, s97, 3
    s_add_u32 s5, s5, s98
    s_lshl_b32 s5, s5, 2
    s_add_u32 s5, s5, s88
    s_lshl_b32 s5, s5, 11
    global_load_dwordx4 v[98:101], v1, s[36:37]
    buffer_load_dwordx4 v[102:105], v1, s[44:47], s5 offen offset:0
    buffer_load_dwordx4 v[106:109], v1, s[44:47], s5 offen offset:1024
    v_subrev_u32 v38, 98304, v20
    v_subrev_u32 v39, 98304, v21
    s_waitcnt lgkmcnt(14)
    ds_read_b64_tr_b16 a[0:1], v20 offset:32768
    s_waitcnt lgkmcnt(14)
    ds_read_b64_tr_b16 a[2:3], v20 offset:33792
    s_waitcnt lgkmcnt(14)
    ds_read_b64_tr_b16 a[4:5], v21 offset:32768
    s_waitcnt lgkmcnt(14)
    ds_read_b64_tr_b16 a[6:7], v21 offset:33792
    s_waitcnt lgkmcnt(14)
    ds_read_b64_tr_b16 a[8:9], v20 offset:34816
    s_waitcnt lgkmcnt(14)
    ds_read_b64_tr_b16 a[10:11], v20 offset:35840
    s_waitcnt lgkmcnt(14)
    ds_read_b64_tr_b16 a[12:13], v21 offset:34816
    s_waitcnt lgkmcnt(14)
    ds_read_b64_tr_b16 a[14:15], v21 offset:35840
    s_waitcnt lgkmcnt(14)
    ds_read_b64_tr_b16 a[16:17], v20 offset:0
    s_waitcnt lgkmcnt(14)
    ds_read_b64_tr_b16 a[18:19], v20 offset:1024
    s_waitcnt lgkmcnt(14)
    ds_read_b64_tr_b16 a[20:21], v21 offset:0
    s_waitcnt lgkmcnt(14)
    ds_read_b64_tr_b16 a[22:23], v21 offset:1024
    s_waitcnt lgkmcnt(14)
    ds_read_b64_tr_b16 a[24:25], v20 offset:2048
    s_waitcnt lgkmcnt(14)
    ds_read_b64_tr_b16 a[26:27], v20 offset:3072
    s_waitcnt lgkmcnt(14)
    ds_read_b64_tr_b16 a[28:29], v21 offset:2048
    s_waitcnt lgkmcnt(14)
    ds_read_b64_tr_b16 a[30:31], v21 offset:3072
    s_waitcnt vmcnt(21)
    s_waitcnt lgkmcnt(14)
    ds_read_b64_tr_b16 a[32:33], v20 offset:4096
    s_waitcnt lgkmcnt(14)
    ds_read_b64_tr_b16 a[34:35], v20 offset:5120
    s_waitcnt lgkmcnt(14)
    ds_read_b64_tr_b16 a[36:37], v21 offset:4096
    s_waitcnt lgkmcnt(14)
    ds_read_b64_tr_b16 a[38:39], v21 offset:5120
    s_waitcnt vmcnt(19)
    s_waitcnt lgkmcnt(14)
    ds_read_b64_tr_b16 a[40:41], v20 offset:6144
    s_waitcnt lgkmcnt(14)
    ds_read_b64_tr_b16 a[42:43], v20 offset:7168
    s_waitcnt lgkmcnt(14)
    ds_read_b64_tr_b16 a[44:45], v21 offset:6144
    s_waitcnt lgkmcnt(14)
    ds_read_b64_tr_b16 a[46:47], v21 offset:7168
    s_waitcnt vmcnt(17)
    s_waitcnt lgkmcnt(14)
    ds_read_b64_tr_b16 a[48:49], v38 offset:0
    s_waitcnt lgkmcnt(14)
    ds_read_b64_tr_b16 a[50:51], v38 offset:1024
    s_waitcnt lgkmcnt(14)
    ds_read_b64_tr_b16 a[52:53], v39 offset:0
    s_waitcnt lgkmcnt(14)
    ds_read_b64_tr_b16 a[54:55], v39 offset:1024
    s_waitcnt vmcnt(15)
    s_waitcnt lgkmcnt(14)
    ds_read_b64_tr_b16 a[56:57], v38 offset:2048
    s_waitcnt lgkmcnt(14)
    ds_read_b64_tr_b16 a[58:59], v38 offset:3072
    s_waitcnt lgkmcnt(14)
    ds_read_b64_tr_b16 a[60:61], v39 offset:2048
    s_waitcnt lgkmcnt(14)
    ds_read_b64_tr_b16 a[62:63], v39 offset:3072
    s_waitcnt vmcnt(13)
    s_waitcnt lgkmcnt(14)
    ds_read_b64_tr_b16 a[64:65], v38 offset:4096
    s_waitcnt lgkmcnt(14)
    ds_read_b64_tr_b16 a[66:67], v38 offset:5120
    s_waitcnt lgkmcnt(14)
    ds_read_b64_tr_b16 a[68:69], v39 offset:4096
    s_waitcnt lgkmcnt(14)
    ds_read_b64_tr_b16 a[70:71], v39 offset:5120
    s_waitcnt vmcnt(11)
    s_waitcnt lgkmcnt(14)
    ds_read_b64_tr_b16 a[72:73], v38 offset:6144
    s_waitcnt lgkmcnt(14)
    ds_read_b64_tr_b16 a[74:75], v38 offset:7168
    s_waitcnt lgkmcnt(14)
    ds_read_b64_tr_b16 a[76:77], v39 offset:6144
    s_waitcnt lgkmcnt(14)
    ds_read_b64_tr_b16 a[78:79], v39 offset:7168
    s_and_b32 s5, s88, 1
    s_mul_i32 s7, s5, 2304
    s_lshl_b32 s6, s88, 14
    s_add_u32 s6, s6, 44208
    s_add_u32 s6, s6, s7
    v_lshrrev_b32 v30, 3, v0
    v_mul_u32_u24 v30, 144, v30
    v_and_b32 v31, 7, v0
    v_lshl_add_u32 v30, v31, 4, v30
    v_add_u32 v110, s6, v30
    s_sub_u32 s7, 2304, s7
    v_add_u32 v111, s7, v110
    s_waitcnt vmcnt(4) lgkmcnt(14)
    ds_write_b128 v111, v[120:123] offset:0
    s_waitcnt vmcnt(3) lgkmcnt(14)
    ds_write_b128 v111, v[124:127] offset:1152
    s_waitcnt lgkmcnt(14)
    ds_write_b128 v110, v[112:115] offset:0
    s_waitcnt lgkmcnt(14)
    ds_write_b128 v110, v[116:119] offset:1152
    s_mov_b64 s[60:61], s[42:43]
    s_mov_b32 s62, 0
    s_mov_b32 s63, 0x20000
    s_mov_b32 s95, 0
    s_mov_b32 s13, 0
    s_waitcnt vmcnt(0) lgkmcnt(0)
    s_nop 7
    s_branch L_join
L_codeend:
.section .rodata,"a"
.p2align 6
.amdhsa_kernel gated_mix__ssm_conv_h3__glu_gated_reglu__prompt_kernel
  .amdhsa_next_free_vgpr 512
  .amdhsa_next_free_sgpr 102
  .amdhsa_accum_offset 256
  .amdhsa_group_segment_fixed_size 0
  .amdhsa_kernarg_size 112
  .amdhsa_user_sgpr_count 2
  .amdhsa_user_sgpr_kernarg_segment_ptr 1
  .amdhsa_system_sgpr_workgroup_id_x 1
  .amdhsa_float_denorm_mode_32 3
.end_amdhsa_kernel
```
